```python
import torch

def _softmax(x, axis=-1):
    return torch.softmax(x, dim=axis)
def _gelu(x):
    return torch.nn.functional.gelu(x, approximate="tanh")
def _silu(x):
    return torch.nn.functional.silu(x)
def _sigmoid(x):
    return torch.sigmoid(x)
def _layernorm(x, axis=-1, eps=1e-5):
    m = x.mean(dim=axis, keepdim=True)
    v = x.var(dim=axis, keepdim=True, unbiased=False)
    return (x - m) / torch.sqrt(v + eps)
def _scatter_add(tgt, idx, src, axis=0):
    return tgt.clone().index_add_(axis, idx, src)
def _segment_sum(src, seg, n):
    out = torch.zeros((n,) + src.shape[1:], dtype=src.dtype)
    return out.index_add_(0, seg, src)
def _pad(x, pw):
    flat = tuple(v for pair in reversed(pw) for v in pair)
    return torch.nn.functional.pad(x, flat)

kernel_name = 'gated_mix__softmax_full_mha__dense_activation_squared_relu__prompt'

def setup_inputs():

    _w = (lambda a: (lambda t: t.to(torch.bfloat16) if t.is_floating_point() else t)(torch.as_tensor(a)))
    def _A_setup():
        B, S, D = 1, 2048, 512
        return {
            "x": _w((lambda *s: torch.randn(*s, dtype=torch.bfloat16) * 0.05)(B, S, D)),
            "wqkv": _w((lambda *s: torch.randn(*s, dtype=torch.bfloat16) * 0.8)(D, 3 * D)),
            "wo": _w((lambda *s: torch.randn(*s, dtype=torch.bfloat16) * 0.1)(D, D)),
        }
    _A_in = _A_setup()

    def _B_setup():
        B, S, D, F = 1, 2048, 512, 1792
        return {
            "x": _w((lambda *s: torch.randn(*s, dtype=torch.bfloat16) * 0.05)(B, S, D)),
            "w1": _w((lambda *s: torch.randn(*s, dtype=torch.bfloat16) * 0.1)(D, F)),
            "b1": _w((lambda *s: torch.randn(*s, dtype=torch.bfloat16) * 0.05)(F)),
            "w2": _w((lambda *s: torch.randn(*s, dtype=torch.bfloat16) * 0.05)(F, D)),
            "b2": _w((lambda *s: torch.randn(*s, dtype=torch.bfloat16) * 0.05)(D)),
        }
    _B_in = _B_setup()

    return {
        "A_x": _A_in["x"],
        "A_wqkv": _A_in["wqkv"],
        "A_wo": _A_in["wo"],
        "B_x": _B_in["x"],
        "B_w1": _B_in["w1"],
        "B_b1": _B_in["b1"],
        "B_w2": _B_in["w2"],
        "B_b2": _B_in["b2"],
        "gate_w": _w((lambda *s: torch.randn(*s, dtype=torch.bfloat16) * 0.05)(512) * 16.0),
    }

def reference(A_x, A_wqkv, A_wo, B_x, B_w1, B_b1, B_w2, B_b2, gate_w):
    def _A_ref(x, wqkv, wo):
        B, S, D = x.shape
        H = 32; Dh = D // H
        qkv = (lambda x, *d: x.permute(*d))((x @ wqkv).reshape(B, S, 3, H, Dh), 2, 0, 3, 1, 4)
        q, k, v = qkv[0], qkv[1], qkv[2]
        scale = Dh ** -0.5
        scores = torch.einsum("bhqd,bhkd->bhqk", q, k) * scale
        p = _softmax(scores, axis=-1)
        o = torch.einsum("bhqk,bhkd->bhqd", p, v)
        return (lambda x, *d: x.permute(*d))(o, 0, 2, 1, 3).reshape(B, S, D) @ wo

    def _B_ref(x, w1, b1, w2, b2):
        h = torch.einsum("bsd,df->bsf", x, w1) + b1
        zero = torch.zeros_like(h)
        r = torch.where(h > zero, h, zero)
        h = r * r
        out = torch.einsum("bsf,fd->bsd", h, w2) + b2
        return out

    x = A_x
    g = _sigmoid((x * gate_w).sum(-1, keepdims=True))
    a = _A_ref(x, A_wqkv, A_wo)
    b = _B_ref(x, B_w1, B_b1, B_w2, B_b2)
    return g * a + (1 - g) * b
```

```asm
; @launch kernel=k1_kernel grid=(240,1,1) block=(512,1,1) lds=147456
; @launch kernel=k2_kernel grid=(256,1,1) block=(768,1,1) lds=139264
; @launch kernel=k3_kernel grid=(256,1,1) block=(256,1,1) lds=65536
.amdgcn_target "amdgcn-amd-amdhsa--gfx950"
.text
.globl k1_kernel
.p2align 8
.type k1_kernel,@function
k1_kernel:
    s_cmp_ge_u32 s2, 240
    s_cbranch_scc1 k1_kernel_end
    s_load_dwordx2 s[4:5], s[0:1], 0
    s_load_dwordx2 s[6:7], s[0:1], 8
    s_load_dwordx2 s[24:25], s[0:1], 32
    s_load_dwordx2 s[26:27], s[0:1], 40
    s_load_dwordx2 s[28:29], s[0:1], 88
    v_and_b32 v1, 63, v0
    v_lshrrev_b32 v2, 6, v0
    s_nop 0
    v_readfirstlane_b32 s30, v2
    s_waitcnt lgkmcnt(0)
    s_cmp_ge_u32 s2, 208
    s_cbranch_scc1 k1_kernel_aux
    s_and_b32 s38, s2, 7
    s_lshr_b32 s39, s2, 3
    s_cmp_lt_u32 s39, 24
    s_cbranch_scc1 k1_kernel_map_main
    s_mov_b32 s32, 12
    s_lshl_b32 s31, s38, 1
    s_add_u32 s31, s31, s39
    s_sub_u32 s31, s31, 24
    s_branch k1_kernel_map_done
k1_kernel_map_main:
    s_and_b32 s31, s38, 1
    s_lshl_b32 s31, s31, 3
    s_and_b32 s32, s39, 7
    s_add_u32 s31, s31, s32
    s_lshr_b32 s38, s38, 1
    s_mul_i32 s38, s38, 3
    s_lshr_b32 s32, s39, 3
    s_add_u32 s32, s32, s38
k1_kernel_map_done:
    s_mov_b32 s8, s4
    s_and_b32 s9, s5, 0xffff
    s_mov_b32 s10, 2097152
    s_mov_b32 s11, 0x20000
    s_mov_b32 s16, s28
    s_and_b32 s17, s29, 0xffff
    s_mov_b32 s18, 23068672
    s_mov_b32 s19, 0x20000
    s_cmp_lt_u32 s32, 6
    s_cbranch_scc1 k1_kernel_isqkv
    s_sub_u32 s38, s32, 6
    s_lshl_b32 s38, s38, 9
    s_add_u32 s12, s24, s38
    s_addc_u32 s13, s25, 0
    s_and_b32 s13, s13, 0xffff
    s_sub_u32 s14, 1835008, s38
    s_mov_b32 s33, 3584
    s_branch k1_kernel_wsel
k1_kernel_isqkv:
    s_lshl_b32 s38, s32, 9
    s_add_u32 s12, s6, s38
    s_addc_u32 s13, s7, 0
    s_and_b32 s13, s13, 0xffff
    s_sub_u32 s14, 1572864, s38
    s_mov_b32 s33, 3072
k1_kernel_wsel:
    s_mov_b32 s15, 0x20000
    v_lshrrev_b32 v14, 3, v1
    v_lshlrev_b32 v14, 10, v14
    v_lshrrev_b32 v15, 4, v1
    v_and_b32 v16, 7, v1
    v_xor_b32 v17, v16, v15
    v_lshl_add_u32 v2, v17, 4, v14
    v_add_u32 v15, 4, v15
    v_xor_b32 v17, v16, v15
    v_lshl_add_u32 v3, v17, 4, v14
    v_add_u32 v3, 8192, v3
    v_lshrrev_b32 v14, 5, v1
    v_mul_lo_u32 v15, v14, s33
    v_and_b32 v16, 31, v1
    v_add_u32 v17, 0, v14
    v_lshlrev_b32 v17, 2, v17
    v_xor_b32 v17, v16, v17
    v_lshl_add_u32 v4, v17, 4, v15
    v_add_u32 v17, 2, v14
    v_lshlrev_b32 v17, 2, v17
    v_xor_b32 v17, v16, v17
    v_lshl_add_u32 v5, v17, 4, v15
    s_mul_i32 s38, s33, 2
    v_add_u32 v5, s38, v5
    v_add_u32 v17, 0, v14
    v_lshlrev_b32 v17, 2, v17
    v_xor_b32 v17, v16, v17
    v_lshl_add_u32 v6, v17, 4, v15
    s_mul_i32 s38, s33, 4
    v_add_u32 v6, s38, v6
    v_add_u32 v17, 2, v14
    v_lshlrev_b32 v17, 2, v17
    v_xor_b32 v17, v16, v17
    v_lshl_add_u32 v7, v17, 4, v15
    s_mul_i32 s38, s33, 6
    v_add_u32 v7, s38, v7
    s_lshl_b32 s34, s31, 7
    s_lshl_b32 s38, s30, 4
    s_add_u32 s34, s34, s38
    s_lshl_b32 s34, s34, 10
    s_lshl_b32 s38, s30, 3
    s_mul_i32 s35, s38, s33
    s_lshl_b32 s36, s30, 11
    s_lshl_b32 s37, s30, 12
    s_add_u32 s37, s37, 49152
    s_cmp_lt_u32 s32, 6
    s_cbranch_scc1 k1_kernel_nobias
    s_mov_b32 s20, s26
    s_and_b32 s21, s27, 0xffff
    s_mov_b32 s22, 3584
    s_mov_b32 s23, 0x20000
    s_sub_u32 s38, s32, 6
    s_lshl_b32 s38, s38, 8
    s_and_b32 s39, s30, 3
    s_lshl_b32 s39, s39, 6
    s_add_u32 s38, s38, s39
    s_lshl_b32 s38, s38, 1
    v_lshrrev_b32 v14, 5, v1
    v_lshlrev_b32 v14, 3, v14
    buffer_load_dwordx2 v[128:129], v14, s[20:23], s38 offen offset:0
    buffer_load_dwordx2 v[130:131], v14, s[20:23], s38 offen offset:16
    buffer_load_dwordx2 v[132:133], v14, s[20:23], s38 offen offset:32
    buffer_load_dwordx2 v[134:135], v14, s[20:23], s38 offen offset:48
    buffer_load_dwordx2 v[136:137], v14, s[20:23], s38 offen offset:64
    buffer_load_dwordx2 v[138:139], v14, s[20:23], s38 offen offset:80
    buffer_load_dwordx2 v[140:141], v14, s[20:23], s38 offen offset:96
    buffer_load_dwordx2 v[142:143], v14, s[20:23], s38 offen offset:112
k1_kernel_nobias:
    s_add_u32 m0, s36, 0
    s_nop 0
    buffer_load_dwordx4 v2, s[8:11], s34 offen lds
    s_add_u32 m0, s36, 1024
    s_nop 0
    buffer_load_dwordx4 v3, s[8:11], s34 offen lds
    s_add_u32 m0, s37, 0
    s_nop 0
    buffer_load_dwordx4 v4, s[12:15], s35 offen lds
    s_add_u32 m0, s37, 1024
    s_nop 0
    buffer_load_dwordx4 v5, s[12:15], s35 offen lds
    s_add_u32 m0, s37, 2048
    s_nop 0
    buffer_load_dwordx4 v6, s[12:15], s35 offen lds
    s_add_u32 m0, s37, 3072
    s_nop 0
    buffer_load_dwordx4 v7, s[12:15], s35 offen lds
    s_add_u32 s34, s34, 128
    s_lshl_b32 s38, s33, 6
    s_add_u32 s35, s35, s38
    s_add_u32 m0, s36, 16384
    s_nop 0
    buffer_load_dwordx4 v2, s[8:11], s34 offen lds
    s_add_u32 m0, s36, 17408
    s_nop 0
    buffer_load_dwordx4 v3, s[8:11], s34 offen lds
    s_add_u32 m0, s37, 32768
    s_nop 0
    buffer_load_dwordx4 v4, s[12:15], s35 offen lds
    s_add_u32 m0, s37, 33792
    s_nop 0
    buffer_load_dwordx4 v5, s[12:15], s35 offen lds
    s_add_u32 m0, s37, 34816
    s_nop 0
    buffer_load_dwordx4 v6, s[12:15], s35 offen lds
    s_add_u32 m0, s37, 35840
    s_nop 0
    buffer_load_dwordx4 v7, s[12:15], s35 offen lds
    s_add_u32 s34, s34, 128
    s_lshl_b32 s38, s33, 6
    s_add_u32 s35, s35, s38
    s_lshr_b32 s41, s30, 2
    s_and_b32 s42, s30, 3
    v_and_b32 v14, 31, v1
    s_lshl_b32 s38, s41, 6
    v_add_u32 v14, s38, v14
    v_lshrrev_b32 v15, 1, v14
    v_and_b32 v15, 7, v15
    v_lshrrev_b32 v16, 5, v1
    v_xor_b32 v15, v15, v16
    v_lshlrev_b32 v15, 4, v15
    v_lshl_add_u32 v8, v14, 7, v15
    v_xor_b32 v9, 32, v8
    v_xor_b32 v10, 64, v8
    v_xor_b32 v11, 96, v8
    v_lshrrev_b32 v14, 2, v1
    v_and_b32 v14, 3, v14
    v_lshrrev_b32 v15, 5, v1
    v_lshl_add_u32 v15, v15, 3, v14
    v_lshlrev_b32 v15, 9, v15
    v_add_u32 v15, 49152, v15
    v_and_b32 v16, 1, v1
    v_lshl_add_u32 v15, v16, 3, v15
    v_lshrrev_b32 v16, 4, v1
    v_and_b32 v16, 1, v16
    v_lshlrev_b32 v16, 1, v16
    v_lshrrev_b32 v17, 1, v1
    v_and_b32 v17, 1, v17
    v_add_u32 v16, v16, v17
    s_lshl_b32 s38, s42, 3
    v_add_u32 v16, s38, v16
    v_lshlrev_b32 v17, 2, v14
    v_add_u32 v18, 0, v16
    v_xor_b32 v18, v18, v17
    v_lshl_add_u32 v12, v18, 4, v15
    v_add_u32 v52, 32768, v12
    v_add_u32 v54, 65536, v12
    v_add_u32 v18, 4, v16
    v_xor_b32 v18, v18, v17
    v_lshl_add_u32 v13, v18, 4, v15
    v_add_u32 v53, 32768, v13
    v_add_u32 v55, 65536, v13
    s_cmp_ge_u32 s32, 6
    s_cbranch_scc1 k1_kernel_initbias
    v_mov_b32 v64, 0
    v_mov_b32 v65, 0
    v_mov_b32 v66, 0
    v_mov_b32 v67, 0
    v_mov_b32 v68, 0
    v_mov_b32 v69, 0
    v_mov_b32 v70, 0
    v_mov_b32 v71, 0
    v_mov_b32 v72, 0
    v_mov_b32 v73, 0
    v_mov_b32 v74, 0
    v_mov_b32 v75, 0
    v_mov_b32 v76, 0
    v_mov_b32 v77, 0
    v_mov_b32 v78, 0
    v_mov_b32 v79, 0
    v_mov_b32 v80, 0
    v_mov_b32 v81, 0
    v_mov_b32 v82, 0
    v_mov_b32 v83, 0
    v_mov_b32 v84, 0
    v_mov_b32 v85, 0
    v_mov_b32 v86, 0
    v_mov_b32 v87, 0
    v_mov_b32 v88, 0
    v_mov_b32 v89, 0
    v_mov_b32 v90, 0
    v_mov_b32 v91, 0
    v_mov_b32 v92, 0
    v_mov_b32 v93, 0
    v_mov_b32 v94, 0
    v_mov_b32 v95, 0
    v_mov_b32 v96, 0
    v_mov_b32 v97, 0
    v_mov_b32 v98, 0
    v_mov_b32 v99, 0
    v_mov_b32 v100, 0
    v_mov_b32 v101, 0
    v_mov_b32 v102, 0
    v_mov_b32 v103, 0
    v_mov_b32 v104, 0
    v_mov_b32 v105, 0
    v_mov_b32 v106, 0
    v_mov_b32 v107, 0
    v_mov_b32 v108, 0
    v_mov_b32 v109, 0
    v_mov_b32 v110, 0
    v_mov_b32 v111, 0
    v_mov_b32 v112, 0
    v_mov_b32 v113, 0
    v_mov_b32 v114, 0
    v_mov_b32 v115, 0
    v_mov_b32 v116, 0
    v_mov_b32 v117, 0
    v_mov_b32 v118, 0
    v_mov_b32 v119, 0
    v_mov_b32 v120, 0
    v_mov_b32 v121, 0
    v_mov_b32 v122, 0
    v_mov_b32 v123, 0
    v_mov_b32 v124, 0
    v_mov_b32 v125, 0
    v_mov_b32 v126, 0
    v_mov_b32 v127, 0
    s_branch k1_kernel_initdone
k1_kernel_initbias:
    s_waitcnt vmcnt(12)
    v_lshlrev_b32 v64, 16, v128
    v_and_b32 v65, 0xffff0000, v128
    v_lshlrev_b32 v96, 16, v128
    v_and_b32 v97, 0xffff0000, v128
    v_lshlrev_b32 v66, 16, v129
    v_and_b32 v67, 0xffff0000, v129
    v_lshlrev_b32 v98, 16, v129
    v_and_b32 v99, 0xffff0000, v129
    v_lshlrev_b32 v68, 16, v130
    v_and_b32 v69, 0xffff0000, v130
    v_lshlrev_b32 v100, 16, v130
    v_and_b32 v101, 0xffff0000, v130
    v_lshlrev_b32 v70, 16, v131
    v_and_b32 v71, 0xffff0000, v131
    v_lshlrev_b32 v102, 16, v131
    v_and_b32 v103, 0xffff0000, v131
    v_lshlrev_b32 v72, 16, v132
    v_and_b32 v73, 0xffff0000, v132
    v_lshlrev_b32 v104, 16, v132
    v_and_b32 v105, 0xffff0000, v132
    v_lshlrev_b32 v74, 16, v133
    v_and_b32 v75, 0xffff0000, v133
    v_lshlrev_b32 v106, 16, v133
    v_and_b32 v107, 0xffff0000, v133
    v_lshlrev_b32 v76, 16, v134
    v_and_b32 v77, 0xffff0000, v134
    v_lshlrev_b32 v108, 16, v134
    v_and_b32 v109, 0xffff0000, v134
    v_lshlrev_b32 v78, 16, v135
    v_and_b32 v79, 0xffff0000, v135
    v_lshlrev_b32 v110, 16, v135
    v_and_b32 v111, 0xffff0000, v135
    v_lshlrev_b32 v80, 16, v136
    v_and_b32 v81, 0xffff0000, v136
    v_lshlrev_b32 v112, 16, v136
    v_and_b32 v113, 0xffff0000, v136
    v_lshlrev_b32 v82, 16, v137
    v_and_b32 v83, 0xffff0000, v137
    v_lshlrev_b32 v114, 16, v137
    v_and_b32 v115, 0xffff0000, v137
    v_lshlrev_b32 v84, 16, v138
    v_and_b32 v85, 0xffff0000, v138
    v_lshlrev_b32 v116, 16, v138
    v_and_b32 v117, 0xffff0000, v138
    v_lshlrev_b32 v86, 16, v139
    v_and_b32 v87, 0xffff0000, v139
    v_lshlrev_b32 v118, 16, v139
    v_and_b32 v119, 0xffff0000, v139
    v_lshlrev_b32 v88, 16, v140
    v_and_b32 v89, 0xffff0000, v140
    v_lshlrev_b32 v120, 16, v140
    v_and_b32 v121, 0xffff0000, v140
    v_lshlrev_b32 v90, 16, v141
    v_and_b32 v91, 0xffff0000, v141
    v_lshlrev_b32 v122, 16, v141
    v_and_b32 v123, 0xffff0000, v141
    v_lshlrev_b32 v92, 16, v142
    v_and_b32 v93, 0xffff0000, v142
    v_lshlrev_b32 v124, 16, v142
    v_and_b32 v125, 0xffff0000, v142
    v_lshlrev_b32 v94, 16, v143
    v_and_b32 v95, 0xffff0000, v143
    v_lshlrev_b32 v126, 16, v143
    v_and_b32 v127, 0xffff0000, v143
k1_kernel_initdone:
    s_cmp_eq_u32 s32, 4
    s_cbranch_scc1 k1_kernel_loopD
    s_cmp_eq_u32 s32, 5
    s_cbranch_scc1 k1_kernel_loopD
    s_waitcnt vmcnt(6)
    s_barrier
    s_add_u32 m0, s36, 32768
    s_nop 0
    buffer_load_dwordx4 v2, s[8:11], s34 offen lds
    s_add_u32 m0, s36, 33792
    s_nop 0
    buffer_load_dwordx4 v3, s[8:11], s34 offen lds
    s_add_u32 m0, s37, 65536
    s_nop 0
    buffer_load_dwordx4 v4, s[12:15], s35 offen lds
    s_add_u32 m0, s37, 66560
    s_nop 0
    buffer_load_dwordx4 v5, s[12:15], s35 offen lds
    s_add_u32 m0, s37, 67584
    s_nop 0
    buffer_load_dwordx4 v6, s[12:15], s35 offen lds
    s_add_u32 m0, s37, 68608
    s_nop 0
    buffer_load_dwordx4 v7, s[12:15], s35 offen lds
    s_add_u32 s34, s34, 128
    s_lshl_b32 s38, s33, 6
    s_add_u32 s35, s35, s38
    ds_read_b128 v[20:23], v8 offset:0
    ds_read_b128 v[24:27], v8 offset:4096
    ds_read_b64_tr_b16 v[36:37], v12 offset:0
    ds_read_b64_tr_b16 v[38:39], v12 offset:2048
    ds_read_b64_tr_b16 v[40:41], v13 offset:0
    ds_read_b64_tr_b16 v[42:43], v13 offset:2048
    ds_read_b128 v[28:31], v9 offset:0
    ds_read_b128 v[32:35], v9 offset:4096
    ds_read_b64_tr_b16 v[44:45], v12 offset:8192
    ds_read_b64_tr_b16 v[46:47], v12 offset:10240
    ds_read_b64_tr_b16 v[48:49], v13 offset:8192
    ds_read_b64_tr_b16 v[50:51], v13 offset:10240
    s_waitcnt lgkmcnt(6)
    v_mfma_f32_32x32x16_bf16 v[64:79], v[36:39], v[20:23], v[64:79]
    v_mfma_f32_32x32x16_bf16 v[80:95], v[40:43], v[20:23], v[80:95]
    v_mfma_f32_32x32x16_bf16 v[96:111], v[36:39], v[24:27], v[96:111]
    v_mfma_f32_32x32x16_bf16 v[112:127], v[40:43], v[24:27], v[112:127]
    ds_read_b128 v[20:23], v10 offset:0
    ds_read_b128 v[24:27], v10 offset:4096
    ds_read_b64_tr_b16 v[36:37], v12 offset:16384
    ds_read_b64_tr_b16 v[38:39], v12 offset:18432
    ds_read_b64_tr_b16 v[40:41], v13 offset:16384
    ds_read_b64_tr_b16 v[42:43], v13 offset:18432
    s_waitcnt lgkmcnt(6)
    v_mfma_f32_32x32x16_bf16 v[64:79], v[44:47], v[28:31], v[64:79]
    v_mfma_f32_32x32x16_bf16 v[80:95], v[48:51], v[28:31], v[80:95]
    v_mfma_f32_32x32x16_bf16 v[96:111], v[44:47], v[32:35], v[96:111]
    v_mfma_f32_32x32x16_bf16 v[112:127], v[48:51], v[32:35], v[112:127]
    ds_read_b128 v[28:31], v11 offset:0
    ds_read_b128 v[32:35], v11 offset:4096
    ds_read_b64_tr_b16 v[44:45], v12 offset:24576
    ds_read_b64_tr_b16 v[46:47], v12 offset:26624
    ds_read_b64_tr_b16 v[48:49], v13 offset:24576
    ds_read_b64_tr_b16 v[50:51], v13 offset:26624
    s_waitcnt lgkmcnt(6)
    v_mfma_f32_32x32x16_bf16 v[64:79], v[36:39], v[20:23], v[64:79]
    v_mfma_f32_32x32x16_bf16 v[80:95], v[40:43], v[20:23], v[80:95]
    v_mfma_f32_32x32x16_bf16 v[96:111], v[36:39], v[24:27], v[96:111]
    v_mfma_f32_32x32x16_bf16 v[112:127], v[40:43], v[24:27], v[112:127]
    s_waitcnt lgkmcnt(0)
    s_waitcnt vmcnt(6)
    s_barrier
    s_add_u32 m0, s36, 0
    s_nop 0
    buffer_load_dwordx4 v2, s[8:11], s34 offen lds
    s_add_u32 m0, s36, 1024
    s_nop 0
    buffer_load_dwordx4 v3, s[8:11], s34 offen lds
    s_add_u32 m0, s37, 0
    s_nop 0
    buffer_load_dwordx4 v4, s[12:15], s35 offen lds
    s_add_u32 m0, s37, 1024
    s_nop 0
    buffer_load_dwordx4 v5, s[12:15], s35 offen lds
    s_add_u32 m0, s37, 2048
    s_nop 0
    buffer_load_dwordx4 v6, s[12:15], s35 offen lds
    s_add_u32 m0, s37, 3072
    s_nop 0
    buffer_load_dwordx4 v7, s[12:15], s35 offen lds
    s_add_u32 s34, s34, 128
    s_lshl_b32 s38, s33, 6
    s_add_u32 s35, s35, s38
    ds_read_b128 v[20:23], v8 offset:16384
    ds_read_b128 v[24:27], v8 offset:20480
    ds_read_b64_tr_b16 v[36:37], v52 offset:0
    ds_read_b64_tr_b16 v[38:39], v52 offset:2048
    ds_read_b64_tr_b16 v[40:41], v53 offset:0
    ds_read_b64_tr_b16 v[42:43], v53 offset:2048
    v_mfma_f32_32x32x16_bf16 v[64:79], v[44:47], v[28:31], v[64:79]
    v_mfma_f32_32x32x16_bf16 v[80:95], v[48:51], v[28:31], v[80:95]
    v_mfma_f32_32x32x16_bf16 v[96:111], v[44:47], v[32:35], v[96:111]
    v_mfma_f32_32x32x16_bf16 v[112:127], v[48:51], v[32:35], v[112:127]
    ds_read_b128 v[28:31], v9 offset:16384
    ds_read_b128 v[32:35], v9 offset:20480
    ds_read_b64_tr_b16 v[44:45], v52 offset:8192
    ds_read_b64_tr_b16 v[46:47], v52 offset:10240
    ds_read_b64_tr_b16 v[48:49], v53 offset:8192
    ds_read_b64_tr_b16 v[50:51], v53 offset:10240
    s_waitcnt lgkmcnt(6)
    v_mfma_f32_32x32x16_bf16 v[64:79], v[36:39], v[20:23], v[64:79]
    v_mfma_f32_32x32x16_bf16 v[80:95], v[40:43], v[20:23], v[80:95]
    v_mfma_f32_32x32x16_bf16 v[96:111], v[36:39], v[24:27], v[96:111]
    v_mfma_f32_32x32x16_bf16 v[112:127], v[40:43], v[24:27], v[112:127]
    ds_read_b128 v[20:23], v10 offset:16384
    ds_read_b128 v[24:27], v10 offset:20480
    ds_read_b64_tr_b16 v[36:37], v52 offset:16384
    ds_read_b64_tr_b16 v[38:39], v52 offset:18432
    ds_read_b64_tr_b16 v[40:41], v53 offset:16384
    ds_read_b64_tr_b16 v[42:43], v53 offset:18432
    s_waitcnt lgkmcnt(6)
    v_mfma_f32_32x32x16_bf16 v[64:79], v[44:47], v[28:31], v[64:79]
    v_mfma_f32_32x32x16_bf16 v[80:95], v[48:51], v[28:31], v[80:95]
    v_mfma_f32_32x32x16_bf16 v[96:111], v[44:47], v[32:35], v[96:111]
    v_mfma_f32_32x32x16_bf16 v[112:127], v[48:51], v[32:35], v[112:127]
    ds_read_b128 v[28:31], v11 offset:16384
    ds_read_b128 v[32:35], v11 offset:20480
    ds_read_b64_tr_b16 v[44:45], v52 offset:24576
    ds_read_b64_tr_b16 v[46:47], v52 offset:26624
    ds_read_b64_tr_b16 v[48:49], v53 offset:24576
    ds_read_b64_tr_b16 v[50:51], v53 offset:26624
    s_waitcnt lgkmcnt(6)
    v_mfma_f32_32x32x16_bf16 v[64:79], v[36:39], v[20:23], v[64:79]
    v_mfma_f32_32x32x16_bf16 v[80:95], v[40:43], v[20:23], v[80:95]
    v_mfma_f32_32x32x16_bf16 v[96:111], v[36:39], v[24:27], v[96:111]
    v_mfma_f32_32x32x16_bf16 v[112:127], v[40:43], v[24:27], v[112:127]
    s_waitcnt lgkmcnt(0)
    s_waitcnt vmcnt(6)
    s_barrier
    s_add_u32 m0, s36, 16384
    s_nop 0
    buffer_load_dwordx4 v2, s[8:11], s34 offen lds
    s_add_u32 m0, s36, 17408
    s_nop 0
    buffer_load_dwordx4 v3, s[8:11], s34 offen lds
    s_add_u32 m0, s37, 32768
    s_nop 0
    buffer_load_dwordx4 v4, s[12:15], s35 offen lds
    s_add_u32 m0, s37, 33792
    s_nop 0
    buffer_load_dwordx4 v5, s[12:15], s35 offen lds
    s_add_u32 m0, s37, 34816
    s_nop 0
    buffer_load_dwordx4 v6, s[12:15], s35 offen lds
    s_add_u32 m0, s37, 35840
    s_nop 0
    buffer_load_dwordx4 v7, s[12:15], s35 offen lds
    s_add_u32 s34, s34, 128
    s_lshl_b32 s38, s33, 6
    s_add_u32 s35, s35, s38
    ds_read_b128 v[20:23], v8 offset:32768
    ds_read_b128 v[24:27], v8 offset:36864
    ds_read_b64_tr_b16 v[36:37], v54 offset:0
    ds_read_b64_tr_b16 v[38:39], v54 offset:2048
    ds_read_b64_tr_b16 v[40:41], v55 offset:0
    ds_read_b64_tr_b16 v[42:43], v55 offset:2048
    v_mfma_f32_32x32x16_bf16 v[64:79], v[44:47], v[28:31], v[64:79]
    v_mfma_f32_32x32x16_bf16 v[80:95], v[48:51], v[28:31], v[80:95]
    v_mfma_f32_32x32x16_bf16 v[96:111], v[44:47], v[32:35], v[96:111]
    v_mfma_f32_32x32x16_bf16 v[112:127], v[48:51], v[32:35], v[112:127]
    ds_read_b128 v[28:31], v9 offset:32768
    ds_read_b128 v[32:35], v9 offset:36864
    ds_read_b64_tr_b16 v[44:45], v54 offset:8192
    ds_read_b64_tr_b16 v[46:47], v54 offset:10240
    ds_read_b64_tr_b16 v[48:49], v55 offset:8192
    ds_read_b64_tr_b16 v[50:51], v55 offset:10240
    s_waitcnt lgkmcnt(6)
    v_mfma_f32_32x32x16_bf16 v[64:79], v[36:39], v[20:23], v[64:79]
    v_mfma_f32_32x32x16_bf16 v[80:95], v[40:43], v[20:23], v[80:95]
    v_mfma_f32_32x32x16_bf16 v[96:111], v[36:39], v[24:27], v[96:111]
    v_mfma_f32_32x32x16_bf16 v[112:127], v[40:43], v[24:27], v[112:127]
    ds_read_b128 v[20:23], v10 offset:32768
    ds_read_b128 v[24:27], v10 offset:36864
    ds_read_b64_tr_b16 v[36:37], v54 offset:16384
    ds_read_b64_tr_b16 v[38:39], v54 offset:18432
    ds_read_b64_tr_b16 v[40:41], v55 offset:16384
    ds_read_b64_tr_b16 v[42:43], v55 offset:18432
    s_waitcnt lgkmcnt(6)
    v_mfma_f32_32x32x16_bf16 v[64:79], v[44:47], v[28:31], v[64:79]
    v_mfma_f32_32x32x16_bf16 v[80:95], v[48:51], v[28:31], v[80:95]
    v_mfma_f32_32x32x16_bf16 v[96:111], v[44:47], v[32:35], v[96:111]
    v_mfma_f32_32x32x16_bf16 v[112:127], v[48:51], v[32:35], v[112:127]
    ds_read_b128 v[28:31], v11 offset:32768
    ds_read_b128 v[32:35], v11 offset:36864
    ds_read_b64_tr_b16 v[44:45], v54 offset:24576
    ds_read_b64_tr_b16 v[46:47], v54 offset:26624
    ds_read_b64_tr_b16 v[48:49], v55 offset:24576
    ds_read_b64_tr_b16 v[50:51], v55 offset:26624
    s_waitcnt lgkmcnt(6)
    v_mfma_f32_32x32x16_bf16 v[64:79], v[36:39], v[20:23], v[64:79]
    v_mfma_f32_32x32x16_bf16 v[80:95], v[40:43], v[20:23], v[80:95]
    v_mfma_f32_32x32x16_bf16 v[96:111], v[36:39], v[24:27], v[96:111]
    v_mfma_f32_32x32x16_bf16 v[112:127], v[40:43], v[24:27], v[112:127]
    s_waitcnt lgkmcnt(0)
    s_waitcnt vmcnt(6)
    s_barrier
    s_add_u32 m0, s36, 32768
    s_nop 0
    buffer_load_dwordx4 v2, s[8:11], s34 offen lds
    s_add_u32 m0, s36, 33792
    s_nop 0
    buffer_load_dwordx4 v3, s[8:11], s34 offen lds
    s_add_u32 m0, s37, 65536
    s_nop 0
    buffer_load_dwordx4 v4, s[12:15], s35 offen lds
    s_add_u32 m0, s37, 66560
    s_nop 0
    buffer_load_dwordx4 v5, s[12:15], s35 offen lds
    s_add_u32 m0, s37, 67584
    s_nop 0
    buffer_load_dwordx4 v6, s[12:15], s35 offen lds
    s_add_u32 m0, s37, 68608
    s_nop 0
    buffer_load_dwordx4 v7, s[12:15], s35 offen lds
    s_add_u32 s34, s34, 128
    s_lshl_b32 s38, s33, 6
    s_add_u32 s35, s35, s38
    ds_read_b128 v[20:23], v8 offset:0
    ds_read_b128 v[24:27], v8 offset:4096
    ds_read_b64_tr_b16 v[36:37], v12 offset:0
    ds_read_b64_tr_b16 v[38:39], v12 offset:2048
    ds_read_b64_tr_b16 v[40:41], v13 offset:0
    ds_read_b64_tr_b16 v[42:43], v13 offset:2048
    v_mfma_f32_32x32x16_bf16 v[64:79], v[44:47], v[28:31], v[64:79]
    v_mfma_f32_32x32x16_bf16 v[80:95], v[48:51], v[28:31], v[80:95]
    v_mfma_f32_32x32x16_bf16 v[96:111], v[44:47], v[32:35], v[96:111]
    v_mfma_f32_32x32x16_bf16 v[112:127], v[48:51], v[32:35], v[112:127]
    ds_read_b128 v[28:31], v9 offset:0
    ds_read_b128 v[32:35], v9 offset:4096
    ds_read_b64_tr_b16 v[44:45], v12 offset:8192
    ds_read_b64_tr_b16 v[46:47], v12 offset:10240
    ds_read_b64_tr_b16 v[48:49], v13 offset:8192
    ds_read_b64_tr_b16 v[50:51], v13 offset:10240
    s_waitcnt lgkmcnt(6)
    v_mfma_f32_32x32x16_bf16 v[64:79], v[36:39], v[20:23], v[64:79]
    v_mfma_f32_32x32x16_bf16 v[80:95], v[40:43], v[20:23], v[80:95]
    v_mfma_f32_32x32x16_bf16 v[96:111], v[36:39], v[24:27], v[96:111]
    v_mfma_f32_32x32x16_bf16 v[112:127], v[40:43], v[24:27], v[112:127]
    ds_read_b128 v[20:23], v10 offset:0
    ds_read_b128 v[24:27], v10 offset:4096
    ds_read_b64_tr_b16 v[36:37], v12 offset:16384
    ds_read_b64_tr_b16 v[38:39], v12 offset:18432
    ds_read_b64_tr_b16 v[40:41], v13 offset:16384
    ds_read_b64_tr_b16 v[42:43], v13 offset:18432
    s_waitcnt lgkmcnt(6)
    v_mfma_f32_32x32x16_bf16 v[64:79], v[44:47], v[28:31], v[64:79]
    v_mfma_f32_32x32x16_bf16 v[80:95], v[48:51], v[28:31], v[80:95]
    v_mfma_f32_32x32x16_bf16 v[96:111], v[44:47], v[32:35], v[96:111]
    v_mfma_f32_32x32x16_bf16 v[112:127], v[48:51], v[32:35], v[112:127]
    ds_read_b128 v[28:31], v11 offset:0
    ds_read_b128 v[32:35], v11 offset:4096
    ds_read_b64_tr_b16 v[44:45], v12 offset:24576
    ds_read_b64_tr_b16 v[46:47], v12 offset:26624
    ds_read_b64_tr_b16 v[48:49], v13 offset:24576
    ds_read_b64_tr_b16 v[50:51], v13 offset:26624
    s_waitcnt lgkmcnt(6)
    v_mfma_f32_32x32x16_bf16 v[64:79], v[36:39], v[20:23], v[64:79]
    v_mfma_f32_32x32x16_bf16 v[80:95], v[40:43], v[20:23], v[80:95]
    v_mfma_f32_32x32x16_bf16 v[96:111], v[36:39], v[24:27], v[96:111]
    v_mfma_f32_32x32x16_bf16 v[112:127], v[40:43], v[24:27], v[112:127]
    s_waitcnt lgkmcnt(0)
    s_waitcnt vmcnt(6)
    s_barrier
    s_add_u32 m0, s36, 0
    s_nop 0
    buffer_load_dwordx4 v2, s[8:11], s34 offen lds
    s_add_u32 m0, s36, 1024
    s_nop 0
    buffer_load_dwordx4 v3, s[8:11], s34 offen lds
    s_add_u32 m0, s37, 0
    s_nop 0
    buffer_load_dwordx4 v4, s[12:15], s35 offen lds
    s_add_u32 m0, s37, 1024
    s_nop 0
    buffer_load_dwordx4 v5, s[12:15], s35 offen lds
    s_add_u32 m0, s37, 2048
    s_nop 0
    buffer_load_dwordx4 v6, s[12:15], s35 offen lds
    s_add_u32 m0, s37, 3072
    s_nop 0
    buffer_load_dwordx4 v7, s[12:15], s35 offen lds
    s_add_u32 s34, s34, 128
    s_lshl_b32 s38, s33, 6
    s_add_u32 s35, s35, s38
    ds_read_b128 v[20:23], v8 offset:16384
    ds_read_b128 v[24:27], v8 offset:20480
    ds_read_b64_tr_b16 v[36:37], v52 offset:0
    ds_read_b64_tr_b16 v[38:39], v52 offset:2048
    ds_read_b64_tr_b16 v[40:41], v53 offset:0
    ds_read_b64_tr_b16 v[42:43], v53 offset:2048
    v_mfma_f32_32x32x16_bf16 v[64:79], v[44:47], v[28:31], v[64:79]
    v_mfma_f32_32x32x16_bf16 v[80:95], v[48:51], v[28:31], v[80:95]
    v_mfma_f32_32x32x16_bf16 v[96:111], v[44:47], v[32:35], v[96:111]
    v_mfma_f32_32x32x16_bf16 v[112:127], v[48:51], v[32:35], v[112:127]
    ds_read_b128 v[28:31], v9 offset:16384
    ds_read_b128 v[32:35], v9 offset:20480
    ds_read_b64_tr_b16 v[44:45], v52 offset:8192
    ds_read_b64_tr_b16 v[46:47], v52 offset:10240
    ds_read_b64_tr_b16 v[48:49], v53 offset:8192
    ds_read_b64_tr_b16 v[50:51], v53 offset:10240
    s_waitcnt lgkmcnt(6)
    v_mfma_f32_32x32x16_bf16 v[64:79], v[36:39], v[20:23], v[64:79]
    v_mfma_f32_32x32x16_bf16 v[80:95], v[40:43], v[20:23], v[80:95]
    v_mfma_f32_32x32x16_bf16 v[96:111], v[36:39], v[24:27], v[96:111]
    v_mfma_f32_32x32x16_bf16 v[112:127], v[40:43], v[24:27], v[112:127]
    ds_read_b128 v[20:23], v10 offset:16384
    ds_read_b128 v[24:27], v10 offset:20480
    ds_read_b64_tr_b16 v[36:37], v52 offset:16384
    ds_read_b64_tr_b16 v[38:39], v52 offset:18432
    ds_read_b64_tr_b16 v[40:41], v53 offset:16384
    ds_read_b64_tr_b16 v[42:43], v53 offset:18432
    s_waitcnt lgkmcnt(6)
    v_mfma_f32_32x32x16_bf16 v[64:79], v[44:47], v[28:31], v[64:79]
    v_mfma_f32_32x32x16_bf16 v[80:95], v[48:51], v[28:31], v[80:95]
    v_mfma_f32_32x32x16_bf16 v[96:111], v[44:47], v[32:35], v[96:111]
    v_mfma_f32_32x32x16_bf16 v[112:127], v[48:51], v[32:35], v[112:127]
    ds_read_b128 v[28:31], v11 offset:16384
    ds_read_b128 v[32:35], v11 offset:20480
    ds_read_b64_tr_b16 v[44:45], v52 offset:24576
    ds_read_b64_tr_b16 v[46:47], v52 offset:26624
    ds_read_b64_tr_b16 v[48:49], v53 offset:24576
    ds_read_b64_tr_b16 v[50:51], v53 offset:26624
    s_waitcnt lgkmcnt(6)
    v_mfma_f32_32x32x16_bf16 v[64:79], v[36:39], v[20:23], v[64:79]
    v_mfma_f32_32x32x16_bf16 v[80:95], v[40:43], v[20:23], v[80:95]
    v_mfma_f32_32x32x16_bf16 v[96:111], v[36:39], v[24:27], v[96:111]
    v_mfma_f32_32x32x16_bf16 v[112:127], v[40:43], v[24:27], v[112:127]
    s_waitcnt lgkmcnt(0)
    s_waitcnt vmcnt(6)
    s_barrier
    s_add_u32 m0, s36, 16384
    s_nop 0
    buffer_load_dwordx4 v2, s[8:11], s34 offen lds
    s_add_u32 m0, s36, 17408
    s_nop 0
    buffer_load_dwordx4 v3, s[8:11], s34 offen lds
    s_add_u32 m0, s37, 32768
    s_nop 0
    buffer_load_dwordx4 v4, s[12:15], s35 offen lds
    s_add_u32 m0, s37, 33792
    s_nop 0
    buffer_load_dwordx4 v5, s[12:15], s35 offen lds
    s_add_u32 m0, s37, 34816
    s_nop 0
    buffer_load_dwordx4 v6, s[12:15], s35 offen lds
    s_add_u32 m0, s37, 35840
    s_nop 0
    buffer_load_dwordx4 v7, s[12:15], s35 offen lds
    s_add_u32 s34, s34, 128
    s_lshl_b32 s38, s33, 6
    s_add_u32 s35, s35, s38
    ds_read_b128 v[20:23], v8 offset:32768
    ds_read_b128 v[24:27], v8 offset:36864
    ds_read_b64_tr_b16 v[36:37], v54 offset:0
    ds_read_b64_tr_b16 v[38:39], v54 offset:2048
    ds_read_b64_tr_b16 v[40:41], v55 offset:0
    ds_read_b64_tr_b16 v[42:43], v55 offset:2048
    v_mfma_f32_32x32x16_bf16 v[64:79], v[44:47], v[28:31], v[64:79]
    v_mfma_f32_32x32x16_bf16 v[80:95], v[48:51], v[28:31], v[80:95]
    v_mfma_f32_32x32x16_bf16 v[96:111], v[44:47], v[32:35], v[96:111]
    v_mfma_f32_32x32x16_bf16 v[112:127], v[48:51], v[32:35], v[112:127]
    ds_read_b128 v[28:31], v9 offset:32768
    ds_read_b128 v[32:35], v9 offset:36864
    ds_read_b64_tr_b16 v[44:45], v54 offset:8192
    ds_read_b64_tr_b16 v[46:47], v54 offset:10240
    ds_read_b64_tr_b16 v[48:49], v55 offset:8192
    ds_read_b64_tr_b16 v[50:51], v55 offset:10240
    s_waitcnt lgkmcnt(6)
    v_mfma_f32_32x32x16_bf16 v[64:79], v[36:39], v[20:23], v[64:79]
    v_mfma_f32_32x32x16_bf16 v[80:95], v[40:43], v[20:23], v[80:95]
    v_mfma_f32_32x32x16_bf16 v[96:111], v[36:39], v[24:27], v[96:111]
    v_mfma_f32_32x32x16_bf16 v[112:127], v[40:43], v[24:27], v[112:127]
    ds_read_b128 v[20:23], v10 offset:32768
    ds_read_b128 v[24:27], v10 offset:36864
    ds_read_b64_tr_b16 v[36:37], v54 offset:16384
    ds_read_b64_tr_b16 v[38:39], v54 offset:18432
    ds_read_b64_tr_b16 v[40:41], v55 offset:16384
    ds_read_b64_tr_b16 v[42:43], v55 offset:18432
    s_waitcnt lgkmcnt(6)
    v_mfma_f32_32x32x16_bf16 v[64:79], v[44:47], v[28:31], v[64:79]
    v_mfma_f32_32x32x16_bf16 v[80:95], v[48:51], v[28:31], v[80:95]
    v_mfma_f32_32x32x16_bf16 v[96:111], v[44:47], v[32:35], v[96:111]
    v_mfma_f32_32x32x16_bf16 v[112:127], v[48:51], v[32:35], v[112:127]
    ds_read_b128 v[28:31], v11 offset:32768
    ds_read_b128 v[32:35], v11 offset:36864
    ds_read_b64_tr_b16 v[44:45], v54 offset:24576
    ds_read_b64_tr_b16 v[46:47], v54 offset:26624
    ds_read_b64_tr_b16 v[48:49], v55 offset:24576
    ds_read_b64_tr_b16 v[50:51], v55 offset:26624
    s_waitcnt lgkmcnt(6)
    v_mfma_f32_32x32x16_bf16 v[64:79], v[36:39], v[20:23], v[64:79]
    v_mfma_f32_32x32x16_bf16 v[80:95], v[40:43], v[20:23], v[80:95]
    v_mfma_f32_32x32x16_bf16 v[96:111], v[36:39], v[24:27], v[96:111]
    v_mfma_f32_32x32x16_bf16 v[112:127], v[40:43], v[24:27], v[112:127]
    s_waitcnt lgkmcnt(0)
    s_waitcnt vmcnt(6)
    s_barrier
    ds_read_b128 v[20:23], v8 offset:0
    ds_read_b128 v[24:27], v8 offset:4096
    ds_read_b64_tr_b16 v[36:37], v12 offset:0
    ds_read_b64_tr_b16 v[38:39], v12 offset:2048
    ds_read_b64_tr_b16 v[40:41], v13 offset:0
    ds_read_b64_tr_b16 v[42:43], v13 offset:2048
    v_mfma_f32_32x32x16_bf16 v[64:79], v[44:47], v[28:31], v[64:79]
    v_mfma_f32_32x32x16_bf16 v[80:95], v[48:51], v[28:31], v[80:95]
    v_mfma_f32_32x32x16_bf16 v[96:111], v[44:47], v[32:35], v[96:111]
    v_mfma_f32_32x32x16_bf16 v[112:127], v[48:51], v[32:35], v[112:127]
    ds_read_b128 v[28:31], v9 offset:0
    ds_read_b128 v[32:35], v9 offset:4096
    ds_read_b64_tr_b16 v[44:45], v12 offset:8192
    ds_read_b64_tr_b16 v[46:47], v12 offset:10240
    ds_read_b64_tr_b16 v[48:49], v13 offset:8192
    ds_read_b64_tr_b16 v[50:51], v13 offset:10240
    s_waitcnt lgkmcnt(6)
    v_mfma_f32_32x32x16_bf16 v[64:79], v[36:39], v[20:23], v[64:79]
    v_mfma_f32_32x32x16_bf16 v[80:95], v[40:43], v[20:23], v[80:95]
    v_mfma_f32_32x32x16_bf16 v[96:111], v[36:39], v[24:27], v[96:111]
    v_mfma_f32_32x32x16_bf16 v[112:127], v[40:43], v[24:27], v[112:127]
    ds_read_b128 v[20:23], v10 offset:0
    ds_read_b128 v[24:27], v10 offset:4096
    ds_read_b64_tr_b16 v[36:37], v12 offset:16384
    ds_read_b64_tr_b16 v[38:39], v12 offset:18432
    ds_read_b64_tr_b16 v[40:41], v13 offset:16384
    ds_read_b64_tr_b16 v[42:43], v13 offset:18432
    s_waitcnt lgkmcnt(6)
    v_mfma_f32_32x32x16_bf16 v[64:79], v[44:47], v[28:31], v[64:79]
    v_mfma_f32_32x32x16_bf16 v[80:95], v[48:51], v[28:31], v[80:95]
    v_mfma_f32_32x32x16_bf16 v[96:111], v[44:47], v[32:35], v[96:111]
    v_mfma_f32_32x32x16_bf16 v[112:127], v[48:51], v[32:35], v[112:127]
    ds_read_b128 v[28:31], v11 offset:0
    ds_read_b128 v[32:35], v11 offset:4096
    ds_read_b64_tr_b16 v[44:45], v12 offset:24576
    ds_read_b64_tr_b16 v[46:47], v12 offset:26624
    ds_read_b64_tr_b16 v[48:49], v13 offset:24576
    ds_read_b64_tr_b16 v[50:51], v13 offset:26624
    s_waitcnt lgkmcnt(6)
    v_mfma_f32_32x32x16_bf16 v[64:79], v[36:39], v[20:23], v[64:79]
    v_mfma_f32_32x32x16_bf16 v[80:95], v[40:43], v[20:23], v[80:95]
    v_mfma_f32_32x32x16_bf16 v[96:111], v[36:39], v[24:27], v[96:111]
    v_mfma_f32_32x32x16_bf16 v[112:127], v[40:43], v[24:27], v[112:127]
    s_waitcnt lgkmcnt(0)
    s_waitcnt vmcnt(0)
    s_barrier
    ds_read_b128 v[20:23], v8 offset:16384
    ds_read_b128 v[24:27], v8 offset:20480
    ds_read_b64_tr_b16 v[36:37], v52 offset:0
    ds_read_b64_tr_b16 v[38:39], v52 offset:2048
    ds_read_b64_tr_b16 v[40:41], v53 offset:0
    ds_read_b64_tr_b16 v[42:43], v53 offset:2048
    v_mfma_f32_32x32x16_bf16 v[64:79], v[44:47], v[28:31], v[64:79]
    v_mfma_f32_32x32x16_bf16 v[80:95], v[48:51], v[28:31], v[80:95]
    v_mfma_f32_32x32x16_bf16 v[96:111], v[44:47], v[32:35], v[96:111]
    v_mfma_f32_32x32x16_bf16 v[112:127], v[48:51], v[32:35], v[112:127]
    ds_read_b128 v[28:31], v9 offset:16384
    ds_read_b128 v[32:35], v9 offset:20480
    ds_read_b64_tr_b16 v[44:45], v52 offset:8192
    ds_read_b64_tr_b16 v[46:47], v52 offset:10240
    ds_read_b64_tr_b16 v[48:49], v53 offset:8192
    ds_read_b64_tr_b16 v[50:51], v53 offset:10240
    s_waitcnt lgkmcnt(6)
    v_mfma_f32_32x32x16_bf16 v[64:79], v[36:39], v[20:23], v[64:79]
    v_mfma_f32_32x32x16_bf16 v[80:95], v[40:43], v[20:23], v[80:95]
    v_mfma_f32_32x32x16_bf16 v[96:111], v[36:39], v[24:27], v[96:111]
    v_mfma_f32_32x32x16_bf16 v[112:127], v[40:43], v[24:27], v[112:127]
    ds_read_b128 v[20:23], v10 offset:16384
    ds_read_b128 v[24:27], v10 offset:20480
    ds_read_b64_tr_b16 v[36:37], v52 offset:16384
    ds_read_b64_tr_b16 v[38:39], v52 offset:18432
    ds_read_b64_tr_b16 v[40:41], v53 offset:16384
    ds_read_b64_tr_b16 v[42:43], v53 offset:18432
    s_waitcnt lgkmcnt(6)
    v_mfma_f32_32x32x16_bf16 v[64:79], v[44:47], v[28:31], v[64:79]
    v_mfma_f32_32x32x16_bf16 v[80:95], v[48:51], v[28:31], v[80:95]
    v_mfma_f32_32x32x16_bf16 v[96:111], v[44:47], v[32:35], v[96:111]
    v_mfma_f32_32x32x16_bf16 v[112:127], v[48:51], v[32:35], v[112:127]
    ds_read_b128 v[28:31], v11 offset:16384
    ds_read_b128 v[32:35], v11 offset:20480
    ds_read_b64_tr_b16 v[44:45], v52 offset:24576
    ds_read_b64_tr_b16 v[46:47], v52 offset:26624
    ds_read_b64_tr_b16 v[48:49], v53 offset:24576
    ds_read_b64_tr_b16 v[50:51], v53 offset:26624
    s_waitcnt lgkmcnt(6)
    v_mfma_f32_32x32x16_bf16 v[64:79], v[36:39], v[20:23], v[64:79]
    v_mfma_f32_32x32x16_bf16 v[80:95], v[40:43], v[20:23], v[80:95]
    v_mfma_f32_32x32x16_bf16 v[96:111], v[36:39], v[24:27], v[96:111]
    v_mfma_f32_32x32x16_bf16 v[112:127], v[40:43], v[24:27], v[112:127]
    s_waitcnt lgkmcnt(0)
    v_mfma_f32_32x32x16_bf16 v[64:79], v[44:47], v[28:31], v[64:79]
    v_mfma_f32_32x32x16_bf16 v[80:95], v[48:51], v[28:31], v[80:95]
    v_mfma_f32_32x32x16_bf16 v[96:111], v[44:47], v[32:35], v[96:111]
    v_mfma_f32_32x32x16_bf16 v[112:127], v[48:51], v[32:35], v[112:127]
    s_nop 15
    s_nop 3
    s_cmp_ge_u32 s32, 6
    s_cbranch_scc1 k1_kernel_epi_ffn
    s_and_b32 s38, s32, 1
    s_lshl_b32 s38, s38, 4
    s_lshl_b32 s39, s42, 2
    s_add_u32 s38, s38, s39
    s_lshl_b32 s39, s31, 2
    s_lshl_b32 s40, s41, 1
    s_add_u32 s39, s39, s40
    s_cmp_lt_u32 s32, 2
    s_cbranch_scc1 k1_kernel_epi_q
    s_lshl_b32 s38, s38, 17
    s_lshl_b32 s39, s39, 11
    s_add_u32 s45, s38, s39
    s_add_u32 s45, s45, 2097152
    s_mov_b32 s43, 131072
    s_mov_b32 s44, 2048
    s_branch k1_kernel_epi_qk_store
k1_kernel_epi_q:
    s_lshl_b32 s38, s38, 16
    s_lshl_b32 s39, s39, 10
    s_add_u32 s45, s38, s39
    s_add_u32 s45, s45, 0
    s_mov_b32 s43, 65536
    s_mov_b32 s44, 1024
k1_kernel_epi_qk_store:
    v_lshlrev_b32 v14, 4, v1
    v_cvt_pk_bf16_f32 v128, v64, v65
    v_cvt_pk_bf16_f32 v129, v66, v67
    v_cvt_pk_bf16_f32 v130, v68, v69
    v_cvt_pk_bf16_f32 v131, v70, v71
    s_mul_i32 s38, s43, 0
    s_add_u32 s38, s38, s45
    buffer_store_dwordx4 v[128:131], v14, s[16:19], s38 offen
    v_cvt_pk_bf16_f32 v132, v72, v73
    v_cvt_pk_bf16_f32 v133, v74, v75
    v_cvt_pk_bf16_f32 v134, v76, v77
    v_cvt_pk_bf16_f32 v135, v78, v79
    s_mul_i32 s38, s43, 1
    s_add_u32 s38, s38, s45
    buffer_store_dwordx4 v[132:135], v14, s[16:19], s38 offen
    v_cvt_pk_bf16_f32 v136, v80, v81
    v_cvt_pk_bf16_f32 v137, v82, v83
    v_cvt_pk_bf16_f32 v138, v84, v85
    v_cvt_pk_bf16_f32 v139, v86, v87
    s_mul_i32 s38, s43, 2
    s_add_u32 s38, s38, s45
    buffer_store_dwordx4 v[136:139], v14, s[16:19], s38 offen
    v_cvt_pk_bf16_f32 v140, v88, v89
    v_cvt_pk_bf16_f32 v141, v90, v91
    v_cvt_pk_bf16_f32 v142, v92, v93
    v_cvt_pk_bf16_f32 v143, v94, v95
    s_mul_i32 s38, s43, 3
    s_add_u32 s38, s38, s45
    buffer_store_dwordx4 v[140:143], v14, s[16:19], s38 offen
    v_cvt_pk_bf16_f32 v144, v96, v97
    v_cvt_pk_bf16_f32 v145, v98, v99
    v_cvt_pk_bf16_f32 v146, v100, v101
    v_cvt_pk_bf16_f32 v147, v102, v103
    s_mul_i32 s38, s43, 0
    s_add_u32 s38, s38, s45
    s_add_u32 s38, s38, s44
    buffer_store_dwordx4 v[144:147], v14, s[16:19], s38 offen
    v_cvt_pk_bf16_f32 v148, v104, v105
    v_cvt_pk_bf16_f32 v149, v106, v107
    v_cvt_pk_bf16_f32 v150, v108, v109
    v_cvt_pk_bf16_f32 v151, v110, v111
    s_mul_i32 s38, s43, 1
    s_add_u32 s38, s38, s45
    s_add_u32 s38, s38, s44
    buffer_store_dwordx4 v[148:151], v14, s[16:19], s38 offen
    v_cvt_pk_bf16_f32 v152, v112, v113
    v_cvt_pk_bf16_f32 v153, v114, v115
    v_cvt_pk_bf16_f32 v154, v116, v117
    v_cvt_pk_bf16_f32 v155, v118, v119
    s_mul_i32 s38, s43, 2
    s_add_u32 s38, s38, s45
    s_add_u32 s38, s38, s44
    buffer_store_dwordx4 v[152:155], v14, s[16:19], s38 offen
    v_cvt_pk_bf16_f32 v156, v120, v121
    v_cvt_pk_bf16_f32 v157, v122, v123
    v_cvt_pk_bf16_f32 v158, v124, v125
    v_cvt_pk_bf16_f32 v159, v126, v127
    s_mul_i32 s38, s43, 3
    s_add_u32 s38, s38, s45
    s_add_u32 s38, s38, s44
    buffer_store_dwordx4 v[156:159], v14, s[16:19], s38 offen
    s_cmp_lt_u32 s32, 2
    s_cbranch_scc1 k1_kernel_epi_qk_done
    v_mov_b32 v64, 0
    v_mov_b32 v65, 0
    v_mov_b32 v66, 0
    v_mov_b32 v67, 0
    v_mov_b32 v72, 0
    v_dot2_f32_bf16 v72, v128, v128, v72
    v_dot2_f32_bf16 v72, v129, v129, v72
    v_dot2_f32_bf16 v72, v130, v130, v72
    v_dot2_f32_bf16 v72, v131, v131, v72
    s_nop 2
    v_mov_b32 v73, v72
    s_nop 1
    v_permlane32_swap_b32 v72, v73
    v_add_f32 v72, v72, v73
    v_max_f32 v64, v64, v72
    v_mov_b32 v72, 0
    v_dot2_f32_bf16 v72, v132, v132, v72
    v_dot2_f32_bf16 v72, v133, v133, v72
    v_dot2_f32_bf16 v72, v134, v134, v72
    v_dot2_f32_bf16 v72, v135, v135, v72
    s_nop 2
    v_mov_b32 v73, v72
    s_nop 1
    v_permlane32_swap_b32 v72, v73
    v_add_f32 v72, v72, v73
    v_max_f32 v65, v65, v72
    v_mov_b32 v72, 0
    v_dot2_f32_bf16 v72, v136, v136, v72
    v_dot2_f32_bf16 v72, v137, v137, v72
    v_dot2_f32_bf16 v72, v138, v138, v72
    v_dot2_f32_bf16 v72, v139, v139, v72
    s_nop 2
    v_mov_b32 v73, v72
    s_nop 1
    v_permlane32_swap_b32 v72, v73
    v_add_f32 v72, v72, v73
    v_max_f32 v66, v66, v72
    v_mov_b32 v72, 0
    v_dot2_f32_bf16 v72, v140, v140, v72
    v_dot2_f32_bf16 v72, v141, v141, v72
    v_dot2_f32_bf16 v72, v142, v142, v72
    v_dot2_f32_bf16 v72, v143, v143, v72
    s_nop 2
    v_mov_b32 v73, v72
    s_nop 1
    v_permlane32_swap_b32 v72, v73
    v_add_f32 v72, v72, v73
    v_max_f32 v67, v67, v72
    v_mov_b32 v72, 0
    v_dot2_f32_bf16 v72, v144, v144, v72
    v_dot2_f32_bf16 v72, v145, v145, v72
    v_dot2_f32_bf16 v72, v146, v146, v72
    v_dot2_f32_bf16 v72, v147, v147, v72
    s_nop 2
    v_mov_b32 v73, v72
    s_nop 1
    v_permlane32_swap_b32 v72, v73
    v_add_f32 v72, v72, v73
    v_max_f32 v64, v64, v72
    v_mov_b32 v72, 0
    v_dot2_f32_bf16 v72, v148, v148, v72
    v_dot2_f32_bf16 v72, v149, v149, v72
    v_dot2_f32_bf16 v72, v150, v150, v72
    v_dot2_f32_bf16 v72, v151, v151, v72
    s_nop 2
    v_mov_b32 v73, v72
    s_nop 1
    v_permlane32_swap_b32 v72, v73
    v_add_f32 v72, v72, v73
    v_max_f32 v65, v65, v72
    v_mov_b32 v72, 0
    v_dot2_f32_bf16 v72, v152, v152, v72
    v_dot2_f32_bf16 v72, v153, v153, v72
    v_dot2_f32_bf16 v72, v154, v154, v72
    v_dot2_f32_bf16 v72, v155, v155, v72
    s_nop 2
    v_mov_b32 v73, v72
    s_nop 1
    v_permlane32_swap_b32 v72, v73
    v_add_f32 v72, v72, v73
    v_max_f32 v66, v66, v72
    v_mov_b32 v72, 0
    v_dot2_f32_bf16 v72, v156, v156, v72
    v_dot2_f32_bf16 v72, v157, v157, v72
    v_dot2_f32_bf16 v72, v158, v158, v72
    v_dot2_f32_bf16 v72, v159, v159, v72
    s_nop 2
    v_mov_b32 v73, v72
    s_nop 1
    v_permlane32_swap_b32 v72, v73
    v_add_f32 v72, v72, v73
    v_max_f32 v67, v67, v72
    ds_swizzle_b32 v76, v64 offset:1055
    ds_swizzle_b32 v77, v65 offset:1055
    ds_swizzle_b32 v78, v66 offset:1055
    ds_swizzle_b32 v79, v67 offset:1055
    s_waitcnt lgkmcnt(0)
    v_max_f32 v64, v64, v76
    v_max_f32 v65, v65, v77
    v_max_f32 v66, v66, v78
    v_max_f32 v67, v67, v79
    ds_swizzle_b32 v76, v64 offset:2079
    ds_swizzle_b32 v77, v65 offset:2079
    ds_swizzle_b32 v78, v66 offset:2079
    ds_swizzle_b32 v79, v67 offset:2079
    s_waitcnt lgkmcnt(0)
    v_max_f32 v64, v64, v76
    v_max_f32 v65, v65, v77
    v_max_f32 v66, v66, v78
    v_max_f32 v67, v67, v79
    ds_swizzle_b32 v76, v64 offset:4127
    ds_swizzle_b32 v77, v65 offset:4127
    ds_swizzle_b32 v78, v66 offset:4127
    ds_swizzle_b32 v79, v67 offset:4127
    s_waitcnt lgkmcnt(0)
    v_max_f32 v64, v64, v76
    v_max_f32 v65, v65, v77
    v_max_f32 v66, v66, v78
    v_max_f32 v67, v67, v79
    ds_swizzle_b32 v76, v64 offset:8223
    ds_swizzle_b32 v77, v65 offset:8223
    ds_swizzle_b32 v78, v66 offset:8223
    ds_swizzle_b32 v79, v67 offset:8223
    s_waitcnt lgkmcnt(0)
    v_max_f32 v64, v64, v76
    v_max_f32 v65, v65, v77
    v_max_f32 v66, v66, v78
    v_max_f32 v67, v67, v79
    ds_swizzle_b32 v76, v64 offset:16415
    ds_swizzle_b32 v77, v65 offset:16415
    ds_swizzle_b32 v78, v66 offset:16415
    ds_swizzle_b32 v79, v67 offset:16415
    s_waitcnt lgkmcnt(0)
    v_max_f32 v64, v64, v76
    v_max_f32 v65, v65, v77
    v_max_f32 v66, v66, v78
    v_max_f32 v67, v67, v79
    s_and_b32 s38, s32, 1
    s_lshl_b32 s38, s38, 4
    s_lshl_b32 s39, s42, 2
    s_add_u32 s38, s38, s39
    s_lshl_b32 s38, s38, 7
    s_lshl_b32 s39, s31, 1
    s_add_u32 s39, s39, s41
    s_lshl_b32 s39, s39, 2
    s_add_u32 s38, s38, s39
    s_add_u32 s38, s38, 18939904
    v_mov_b32 v72, 0
    s_mov_b64 exec, 1
    buffer_store_dword v64, v72, s[16:19], s38 offen offset:0
    buffer_store_dword v65, v72, s[16:19], s38 offen offset:128
    buffer_store_dword v66, v72, s[16:19], s38 offen offset:256
    buffer_store_dword v67, v72, s[16:19], s38 offen offset:384
k1_kernel_epi_qk_done:
    s_waitcnt vmcnt(0)
    s_endpgm
k1_kernel_epi_ffn:
    s_sub_u32 s38, s32, 6
    s_lshl_b32 s38, s38, 4
    s_lshl_b32 s39, s42, 2
    s_add_u32 s38, s38, s39
    s_lshl_b32 s39, s31, 2
    s_lshl_b32 s40, s41, 1
    s_add_u32 s39, s39, s40
    s_mul_i32 s39, s39, 112
    s_add_u32 s38, s38, s39
    s_lshl_b32 s38, s38, 10
    s_add_u32 s45, s38, 6291456
    v_lshlrev_b32 v14, 4, v1
    v_cvt_pk_bf16_f32 v128, v64, v65
    v_lshlrev_b32 v64, 16, v128
    v_and_b32 v65, 0xffff0000, v128
    v_max_f32 v64, 0, v64
    v_max_f32 v65, 0, v65
    v_mul_f32 v64, v64, v64
    v_mul_f32 v65, v65, v65
    v_cvt_pk_bf16_f32 v128, v64, v65
    v_cvt_pk_bf16_f32 v129, v66, v67
    v_lshlrev_b32 v66, 16, v129
    v_and_b32 v67, 0xffff0000, v129
    v_max_f32 v66, 0, v66
    v_max_f32 v67, 0, v67
    v_mul_f32 v66, v66, v66
    v_mul_f32 v67, v67, v67
    v_cvt_pk_bf16_f32 v129, v66, v67
    v_cvt_pk_bf16_f32 v130, v68, v69
    v_lshlrev_b32 v68, 16, v130
    v_and_b32 v69, 0xffff0000, v130
    v_max_f32 v68, 0, v68
    v_max_f32 v69, 0, v69
    v_mul_f32 v68, v68, v68
    v_mul_f32 v69, v69, v69
    v_cvt_pk_bf16_f32 v130, v68, v69
    v_cvt_pk_bf16_f32 v131, v70, v71
    v_lshlrev_b32 v70, 16, v131
    v_and_b32 v71, 0xffff0000, v131
    v_max_f32 v70, 0, v70
    v_max_f32 v71, 0, v71
    v_mul_f32 v70, v70, v70
    v_mul_f32 v71, v71, v71
    v_cvt_pk_bf16_f32 v131, v70, v71
    s_add_u32 s38, s45, 0
    buffer_store_dwordx4 v[128:131], v14, s[16:19], s38 offen
    v_cvt_pk_bf16_f32 v132, v72, v73
    v_lshlrev_b32 v72, 16, v132
    v_and_b32 v73, 0xffff0000, v132
    v_max_f32 v72, 0, v72
    v_max_f32 v73, 0, v73
    v_mul_f32 v72, v72, v72
    v_mul_f32 v73, v73, v73
    v_cvt_pk_bf16_f32 v132, v72, v73
    v_cvt_pk_bf16_f32 v133, v74, v75
    v_lshlrev_b32 v74, 16, v133
    v_and_b32 v75, 0xffff0000, v133
    v_max_f32 v74, 0, v74
    v_max_f32 v75, 0, v75
    v_mul_f32 v74, v74, v74
    v_mul_f32 v75, v75, v75
    v_cvt_pk_bf16_f32 v133, v74, v75
    v_cvt_pk_bf16_f32 v134, v76, v77
    v_lshlrev_b32 v76, 16, v134
    v_and_b32 v77, 0xffff0000, v134
    v_max_f32 v76, 0, v76
    v_max_f32 v77, 0, v77
    v_mul_f32 v76, v76, v76
    v_mul_f32 v77, v77, v77
    v_cvt_pk_bf16_f32 v134, v76, v77
    v_cvt_pk_bf16_f32 v135, v78, v79
    v_lshlrev_b32 v78, 16, v135
    v_and_b32 v79, 0xffff0000, v135
    v_max_f32 v78, 0, v78
    v_max_f32 v79, 0, v79
    v_mul_f32 v78, v78, v78
    v_mul_f32 v79, v79, v79
    v_cvt_pk_bf16_f32 v135, v78, v79
    s_add_u32 s38, s45, 1024
    buffer_store_dwordx4 v[132:135], v14, s[16:19], s38 offen
    v_cvt_pk_bf16_f32 v136, v80, v81
    v_lshlrev_b32 v80, 16, v136
    v_and_b32 v81, 0xffff0000, v136
    v_max_f32 v80, 0, v80
    v_max_f32 v81, 0, v81
    v_mul_f32 v80, v80, v80
    v_mul_f32 v81, v81, v81
    v_cvt_pk_bf16_f32 v136, v80, v81
    v_cvt_pk_bf16_f32 v137, v82, v83
    v_lshlrev_b32 v82, 16, v137
    v_and_b32 v83, 0xffff0000, v137
    v_max_f32 v82, 0, v82
    v_max_f32 v83, 0, v83
    v_mul_f32 v82, v82, v82
    v_mul_f32 v83, v83, v83
    v_cvt_pk_bf16_f32 v137, v82, v83
    v_cvt_pk_bf16_f32 v138, v84, v85
    v_lshlrev_b32 v84, 16, v138
    v_and_b32 v85, 0xffff0000, v138
    v_max_f32 v84, 0, v84
    v_max_f32 v85, 0, v85
    v_mul_f32 v84, v84, v84
    v_mul_f32 v85, v85, v85
    v_cvt_pk_bf16_f32 v138, v84, v85
    v_cvt_pk_bf16_f32 v139, v86, v87
    v_lshlrev_b32 v86, 16, v139
    v_and_b32 v87, 0xffff0000, v139
    v_max_f32 v86, 0, v86
    v_max_f32 v87, 0, v87
    v_mul_f32 v86, v86, v86
    v_mul_f32 v87, v87, v87
    v_cvt_pk_bf16_f32 v139, v86, v87
    s_add_u32 s38, s45, 2048
    buffer_store_dwordx4 v[136:139], v14, s[16:19], s38 offen
    v_cvt_pk_bf16_f32 v140, v88, v89
    v_lshlrev_b32 v88, 16, v140
    v_and_b32 v89, 0xffff0000, v140
    v_max_f32 v88, 0, v88
    v_max_f32 v89, 0, v89
    v_mul_f32 v88, v88, v88
    v_mul_f32 v89, v89, v89
    v_cvt_pk_bf16_f32 v140, v88, v89
    v_cvt_pk_bf16_f32 v141, v90, v91
    v_lshlrev_b32 v90, 16, v141
    v_and_b32 v91, 0xffff0000, v141
    v_max_f32 v90, 0, v90
    v_max_f32 v91, 0, v91
    v_mul_f32 v90, v90, v90
    v_mul_f32 v91, v91, v91
    v_cvt_pk_bf16_f32 v141, v90, v91
    v_cvt_pk_bf16_f32 v142, v92, v93
    v_lshlrev_b32 v92, 16, v142
    v_and_b32 v93, 0xffff0000, v142
    v_max_f32 v92, 0, v92
    v_max_f32 v93, 0, v93
    v_mul_f32 v92, v92, v92
    v_mul_f32 v93, v93, v93
    v_cvt_pk_bf16_f32 v142, v92, v93
    v_cvt_pk_bf16_f32 v143, v94, v95
    v_lshlrev_b32 v94, 16, v143
    v_and_b32 v95, 0xffff0000, v143
    v_max_f32 v94, 0, v94
    v_max_f32 v95, 0, v95
    v_mul_f32 v94, v94, v94
    v_mul_f32 v95, v95, v95
    v_cvt_pk_bf16_f32 v143, v94, v95
    s_add_u32 s38, s45, 3072
    buffer_store_dwordx4 v[140:143], v14, s[16:19], s38 offen
    v_cvt_pk_bf16_f32 v144, v96, v97
    v_lshlrev_b32 v96, 16, v144
    v_and_b32 v97, 0xffff0000, v144
    v_max_f32 v96, 0, v96
    v_max_f32 v97, 0, v97
    v_mul_f32 v96, v96, v96
    v_mul_f32 v97, v97, v97
    v_cvt_pk_bf16_f32 v144, v96, v97
    v_cvt_pk_bf16_f32 v145, v98, v99
    v_lshlrev_b32 v98, 16, v145
    v_and_b32 v99, 0xffff0000, v145
    v_max_f32 v98, 0, v98
    v_max_f32 v99, 0, v99
    v_mul_f32 v98, v98, v98
    v_mul_f32 v99, v99, v99
    v_cvt_pk_bf16_f32 v145, v98, v99
    v_cvt_pk_bf16_f32 v146, v100, v101
    v_lshlrev_b32 v100, 16, v146
    v_and_b32 v101, 0xffff0000, v146
    v_max_f32 v100, 0, v100
    v_max_f32 v101, 0, v101
    v_mul_f32 v100, v100, v100
    v_mul_f32 v101, v101, v101
    v_cvt_pk_bf16_f32 v146, v100, v101
    v_cvt_pk_bf16_f32 v147, v102, v103
    v_lshlrev_b32 v102, 16, v147
    v_and_b32 v103, 0xffff0000, v147
    v_max_f32 v102, 0, v102
    v_max_f32 v103, 0, v103
    v_mul_f32 v102, v102, v102
    v_mul_f32 v103, v103, v103
    v_cvt_pk_bf16_f32 v147, v102, v103
    s_add_u32 s38, s45, 114688
    buffer_store_dwordx4 v[144:147], v14, s[16:19], s38 offen
    v_cvt_pk_bf16_f32 v148, v104, v105
    v_lshlrev_b32 v104, 16, v148
    v_and_b32 v105, 0xffff0000, v148
    v_max_f32 v104, 0, v104
    v_max_f32 v105, 0, v105
    v_mul_f32 v104, v104, v104
    v_mul_f32 v105, v105, v105
    v_cvt_pk_bf16_f32 v148, v104, v105
    v_cvt_pk_bf16_f32 v149, v106, v107
    v_lshlrev_b32 v106, 16, v149
    v_and_b32 v107, 0xffff0000, v149
    v_max_f32 v106, 0, v106
    v_max_f32 v107, 0, v107
    v_mul_f32 v106, v106, v106
    v_mul_f32 v107, v107, v107
    v_cvt_pk_bf16_f32 v149, v106, v107
    v_cvt_pk_bf16_f32 v150, v108, v109
    v_lshlrev_b32 v108, 16, v150
    v_and_b32 v109, 0xffff0000, v150
    v_max_f32 v108, 0, v108
    v_max_f32 v109, 0, v109
    v_mul_f32 v108, v108, v108
    v_mul_f32 v109, v109, v109
    v_cvt_pk_bf16_f32 v150, v108, v109
    v_cvt_pk_bf16_f32 v151, v110, v111
    v_lshlrev_b32 v110, 16, v151
    v_and_b32 v111, 0xffff0000, v151
    v_max_f32 v110, 0, v110
    v_max_f32 v111, 0, v111
    v_mul_f32 v110, v110, v110
    v_mul_f32 v111, v111, v111
    v_cvt_pk_bf16_f32 v151, v110, v111
    s_add_u32 s38, s45, 115712
    buffer_store_dwordx4 v[148:151], v14, s[16:19], s38 offen
    v_cvt_pk_bf16_f32 v152, v112, v113
    v_lshlrev_b32 v112, 16, v152
    v_and_b32 v113, 0xffff0000, v152
    v_max_f32 v112, 0, v112
    v_max_f32 v113, 0, v113
    v_mul_f32 v112, v112, v112
    v_mul_f32 v113, v113, v113
    v_cvt_pk_bf16_f32 v152, v112, v113
    v_cvt_pk_bf16_f32 v153, v114, v115
    v_lshlrev_b32 v114, 16, v153
    v_and_b32 v115, 0xffff0000, v153
    v_max_f32 v114, 0, v114
    v_max_f32 v115, 0, v115
    v_mul_f32 v114, v114, v114
    v_mul_f32 v115, v115, v115
    v_cvt_pk_bf16_f32 v153, v114, v115
    v_cvt_pk_bf16_f32 v154, v116, v117
    v_lshlrev_b32 v116, 16, v154
    v_and_b32 v117, 0xffff0000, v154
    v_max_f32 v116, 0, v116
    v_max_f32 v117, 0, v117
    v_mul_f32 v116, v116, v116
    v_mul_f32 v117, v117, v117
    v_cvt_pk_bf16_f32 v154, v116, v117
    v_cvt_pk_bf16_f32 v155, v118, v119
    v_lshlrev_b32 v118, 16, v155
    v_and_b32 v119, 0xffff0000, v155
    v_max_f32 v118, 0, v118
    v_max_f32 v119, 0, v119
    v_mul_f32 v118, v118, v118
    v_mul_f32 v119, v119, v119
    v_cvt_pk_bf16_f32 v155, v118, v119
    s_add_u32 s38, s45, 116736
    buffer_store_dwordx4 v[152:155], v14, s[16:19], s38 offen
    v_cvt_pk_bf16_f32 v156, v120, v121
    v_lshlrev_b32 v120, 16, v156
    v_and_b32 v121, 0xffff0000, v156
    v_max_f32 v120, 0, v120
    v_max_f32 v121, 0, v121
    v_mul_f32 v120, v120, v120
    v_mul_f32 v121, v121, v121
    v_cvt_pk_bf16_f32 v156, v120, v121
    v_cvt_pk_bf16_f32 v157, v122, v123
    v_lshlrev_b32 v122, 16, v157
    v_and_b32 v123, 0xffff0000, v157
    v_max_f32 v122, 0, v122
    v_max_f32 v123, 0, v123
    v_mul_f32 v122, v122, v122
    v_mul_f32 v123, v123, v123
    v_cvt_pk_bf16_f32 v157, v122, v123
    v_cvt_pk_bf16_f32 v158, v124, v125
    v_lshlrev_b32 v124, 16, v158
    v_and_b32 v125, 0xffff0000, v158
    v_max_f32 v124, 0, v124
    v_max_f32 v125, 0, v125
    v_mul_f32 v124, v124, v124
    v_mul_f32 v125, v125, v125
    v_cvt_pk_bf16_f32 v158, v124, v125
    v_cvt_pk_bf16_f32 v159, v126, v127
    v_lshlrev_b32 v126, 16, v159
    v_and_b32 v127, 0xffff0000, v159
    v_max_f32 v126, 0, v126
    v_max_f32 v127, 0, v127
    v_mul_f32 v126, v126, v126
    v_mul_f32 v127, v127, v127
    v_cvt_pk_bf16_f32 v159, v126, v127
    s_add_u32 s38, s45, 117760
    buffer_store_dwordx4 v[156:159], v14, s[16:19], s38 offen
    s_waitcnt vmcnt(0)
    s_endpgm
k1_kernel_loopD:
    s_waitcnt vmcnt(6)
    s_barrier
    s_add_u32 m0, s36, 32768
    s_nop 0
    buffer_load_dwordx4 v2, s[8:11], s34 offen lds
    s_add_u32 m0, s36, 33792
    s_nop 0
    buffer_load_dwordx4 v3, s[8:11], s34 offen lds
    s_add_u32 m0, s37, 65536
    s_nop 0
    buffer_load_dwordx4 v4, s[12:15], s35 offen lds
    s_add_u32 m0, s37, 66560
    s_nop 0
    buffer_load_dwordx4 v5, s[12:15], s35 offen lds
    s_add_u32 m0, s37, 67584
    s_nop 0
    buffer_load_dwordx4 v6, s[12:15], s35 offen lds
    s_add_u32 m0, s37, 68608
    s_nop 0
    buffer_load_dwordx4 v7, s[12:15], s35 offen lds
    s_add_u32 s34, s34, 128
    s_lshl_b32 s38, s33, 6
    s_add_u32 s35, s35, s38
    ds_read_b128 v[20:23], v8 offset:0
    ds_read_b128 v[24:27], v8 offset:4096
    ds_read_b64_tr_b16 v[36:37], v12 offset:0
    ds_read_b64_tr_b16 v[38:39], v12 offset:2048
    ds_read_b64_tr_b16 v[40:41], v13 offset:0
    ds_read_b64_tr_b16 v[42:43], v13 offset:2048
    ds_read_b128 v[28:31], v9 offset:0
    ds_read_b128 v[32:35], v9 offset:4096
    ds_read_b64_tr_b16 v[44:45], v12 offset:8192
    ds_read_b64_tr_b16 v[46:47], v12 offset:10240
    ds_read_b64_tr_b16 v[48:49], v13 offset:8192
    ds_read_b64_tr_b16 v[50:51], v13 offset:10240
    s_waitcnt lgkmcnt(6)
    v_mfma_f32_32x32x16_bf16 v[64:79], v[20:23], v[36:39], v[64:79]
    v_mfma_f32_32x32x16_bf16 v[80:95], v[20:23], v[40:43], v[80:95]
    v_mfma_f32_32x32x16_bf16 v[96:111], v[24:27], v[36:39], v[96:111]
    v_mfma_f32_32x32x16_bf16 v[112:127], v[24:27], v[40:43], v[112:127]
    ds_read_b128 v[20:23], v10 offset:0
    ds_read_b128 v[24:27], v10 offset:4096
    ds_read_b64_tr_b16 v[36:37], v12 offset:16384
    ds_read_b64_tr_b16 v[38:39], v12 offset:18432
    ds_read_b64_tr_b16 v[40:41], v13 offset:16384
    ds_read_b64_tr_b16 v[42:43], v13 offset:18432
    s_waitcnt lgkmcnt(6)
    v_mfma_f32_32x32x16_bf16 v[64:79], v[28:31], v[44:47], v[64:79]
    v_mfma_f32_32x32x16_bf16 v[80:95], v[28:31], v[48:51], v[80:95]
    v_mfma_f32_32x32x16_bf16 v[96:111], v[32:35], v[44:47], v[96:111]
    v_mfma_f32_32x32x16_bf16 v[112:127], v[32:35], v[48:51], v[112:127]
    ds_read_b128 v[28:31], v11 offset:0
    ds_read_b128 v[32:35], v11 offset:4096
    ds_read_b64_tr_b16 v[44:45], v12 offset:24576
    ds_read_b64_tr_b16 v[46:47], v12 offset:26624
    ds_read_b64_tr_b16 v[48:49], v13 offset:24576
    ds_read_b64_tr_b16 v[50:51], v13 offset:26624
    s_waitcnt lgkmcnt(6)
    v_mfma_f32_32x32x16_bf16 v[64:79], v[20:23], v[36:39], v[64:79]
    v_mfma_f32_32x32x16_bf16 v[80:95], v[20:23], v[40:43], v[80:95]
    v_mfma_f32_32x32x16_bf16 v[96:111], v[24:27], v[36:39], v[96:111]
    v_mfma_f32_32x32x16_bf16 v[112:127], v[24:27], v[40:43], v[112:127]
    s_waitcnt lgkmcnt(0)
    s_waitcnt vmcnt(6)
    s_barrier
    s_add_u32 m0, s36, 0
    s_nop 0
    buffer_load_dwordx4 v2, s[8:11], s34 offen lds
    s_add_u32 m0, s36, 1024
    s_nop 0
    buffer_load_dwordx4 v3, s[8:11], s34 offen lds
    s_add_u32 m0, s37, 0
    s_nop 0
    buffer_load_dwordx4 v4, s[12:15], s35 offen lds
    s_add_u32 m0, s37, 1024
    s_nop 0
    buffer_load_dwordx4 v5, s[12:15], s35 offen lds
    s_add_u32 m0, s37, 2048
    s_nop 0
    buffer_load_dwordx4 v6, s[12:15], s35 offen lds
    s_add_u32 m0, s37, 3072
    s_nop 0
    buffer_load_dwordx4 v7, s[12:15], s35 offen lds
    s_add_u32 s34, s34, 128
    s_lshl_b32 s38, s33, 6
    s_add_u32 s35, s35, s38
    ds_read_b128 v[20:23], v8 offset:16384
    ds_read_b128 v[24:27], v8 offset:20480
    ds_read_b64_tr_b16 v[36:37], v52 offset:0
    ds_read_b64_tr_b16 v[38:39], v52 offset:2048
    ds_read_b64_tr_b16 v[40:41], v53 offset:0
    ds_read_b64_tr_b16 v[42:43], v53 offset:2048
    v_mfma_f32_32x32x16_bf16 v[64:79], v[28:31], v[44:47], v[64:79]
    v_mfma_f32_32x32x16_bf16 v[80:95], v[28:31], v[48:51], v[80:95]
    v_mfma_f32_32x32x16_bf16 v[96:111], v[32:35], v[44:47], v[96:111]
    v_mfma_f32_32x32x16_bf16 v[112:127], v[32:35], v[48:51], v[112:127]
    ds_read_b128 v[28:31], v9 offset:16384
    ds_read_b128 v[32:35], v9 offset:20480
    ds_read_b64_tr_b16 v[44:45], v52 offset:8192
    ds_read_b64_tr_b16 v[46:47], v52 offset:10240
    ds_read_b64_tr_b16 v[48:49], v53 offset:8192
    ds_read_b64_tr_b16 v[50:51], v53 offset:10240
    s_waitcnt lgkmcnt(6)
    v_mfma_f32_32x32x16_bf16 v[64:79], v[20:23], v[36:39], v[64:79]
    v_mfma_f32_32x32x16_bf16 v[80:95], v[20:23], v[40:43], v[80:95]
    v_mfma_f32_32x32x16_bf16 v[96:111], v[24:27], v[36:39], v[96:111]
    v_mfma_f32_32x32x16_bf16 v[112:127], v[24:27], v[40:43], v[112:127]
    ds_read_b128 v[20:23], v10 offset:16384
    ds_read_b128 v[24:27], v10 offset:20480
    ds_read_b64_tr_b16 v[36:37], v52 offset:16384
    ds_read_b64_tr_b16 v[38:39], v52 offset:18432
    ds_read_b64_tr_b16 v[40:41], v53 offset:16384
    ds_read_b64_tr_b16 v[42:43], v53 offset:18432
    s_waitcnt lgkmcnt(6)
    v_mfma_f32_32x32x16_bf16 v[64:79], v[28:31], v[44:47], v[64:79]
    v_mfma_f32_32x32x16_bf16 v[80:95], v[28:31], v[48:51], v[80:95]
    v_mfma_f32_32x32x16_bf16 v[96:111], v[32:35], v[44:47], v[96:111]
    v_mfma_f32_32x32x16_bf16 v[112:127], v[32:35], v[48:51], v[112:127]
    ds_read_b128 v[28:31], v11 offset:16384
    ds_read_b128 v[32:35], v11 offset:20480
    ds_read_b64_tr_b16 v[44:45], v52 offset:24576
    ds_read_b64_tr_b16 v[46:47], v52 offset:26624
    ds_read_b64_tr_b16 v[48:49], v53 offset:24576
    ds_read_b64_tr_b16 v[50:51], v53 offset:26624
    s_waitcnt lgkmcnt(6)
    v_mfma_f32_32x32x16_bf16 v[64:79], v[20:23], v[36:39], v[64:79]
    v_mfma_f32_32x32x16_bf16 v[80:95], v[20:23], v[40:43], v[80:95]
    v_mfma_f32_32x32x16_bf16 v[96:111], v[24:27], v[36:39], v[96:111]
    v_mfma_f32_32x32x16_bf16 v[112:127], v[24:27], v[40:43], v[112:127]
    s_waitcnt lgkmcnt(0)
    s_waitcnt vmcnt(6)
    s_barrier
    s_add_u32 m0, s36, 16384
    s_nop 0
    buffer_load_dwordx4 v2, s[8:11], s34 offen lds
    s_add_u32 m0, s36, 17408
    s_nop 0
    buffer_load_dwordx4 v3, s[8:11], s34 offen lds
    s_add_u32 m0, s37, 32768
    s_nop 0
    buffer_load_dwordx4 v4, s[12:15], s35 offen lds
    s_add_u32 m0, s37, 33792
    s_nop 0
    buffer_load_dwordx4 v5, s[12:15], s35 offen lds
    s_add_u32 m0, s37, 34816
    s_nop 0
    buffer_load_dwordx4 v6, s[12:15], s35 offen lds
    s_add_u32 m0, s37, 35840
    s_nop 0
    buffer_load_dwordx4 v7, s[12:15], s35 offen lds
    s_add_u32 s34, s34, 128
    s_lshl_b32 s38, s33, 6
    s_add_u32 s35, s35, s38
    ds_read_b128 v[20:23], v8 offset:32768
    ds_read_b128 v[24:27], v8 offset:36864
    ds_read_b64_tr_b16 v[36:37], v54 offset:0
    ds_read_b64_tr_b16 v[38:39], v54 offset:2048
    ds_read_b64_tr_b16 v[40:41], v55 offset:0
    ds_read_b64_tr_b16 v[42:43], v55 offset:2048
    v_mfma_f32_32x32x16_bf16 v[64:79], v[28:31], v[44:47], v[64:79]
    v_mfma_f32_32x32x16_bf16 v[80:95], v[28:31], v[48:51], v[80:95]
    v_mfma_f32_32x32x16_bf16 v[96:111], v[32:35], v[44:47], v[96:111]
    v_mfma_f32_32x32x16_bf16 v[112:127], v[32:35], v[48:51], v[112:127]
    ds_read_b128 v[28:31], v9 offset:32768
    ds_read_b128 v[32:35], v9 offset:36864
    ds_read_b64_tr_b16 v[44:45], v54 offset:8192
    ds_read_b64_tr_b16 v[46:47], v54 offset:10240
    ds_read_b64_tr_b16 v[48:49], v55 offset:8192
    ds_read_b64_tr_b16 v[50:51], v55 offset:10240
    s_waitcnt lgkmcnt(6)
    v_mfma_f32_32x32x16_bf16 v[64:79], v[20:23], v[36:39], v[64:79]
    v_mfma_f32_32x32x16_bf16 v[80:95], v[20:23], v[40:43], v[80:95]
    v_mfma_f32_32x32x16_bf16 v[96:111], v[24:27], v[36:39], v[96:111]
    v_mfma_f32_32x32x16_bf16 v[112:127], v[24:27], v[40:43], v[112:127]
    ds_read_b128 v[20:23], v10 offset:32768
    ds_read_b128 v[24:27], v10 offset:36864
    ds_read_b64_tr_b16 v[36:37], v54 offset:16384
    ds_read_b64_tr_b16 v[38:39], v54 offset:18432
    ds_read_b64_tr_b16 v[40:41], v55 offset:16384
    ds_read_b64_tr_b16 v[42:43], v55 offset:18432
    s_waitcnt lgkmcnt(6)
    v_mfma_f32_32x32x16_bf16 v[64:79], v[28:31], v[44:47], v[64:79]
    v_mfma_f32_32x32x16_bf16 v[80:95], v[28:31], v[48:51], v[80:95]
    v_mfma_f32_32x32x16_bf16 v[96:111], v[32:35], v[44:47], v[96:111]
    v_mfma_f32_32x32x16_bf16 v[112:127], v[32:35], v[48:51], v[112:127]
    ds_read_b128 v[28:31], v11 offset:32768
    ds_read_b128 v[32:35], v11 offset:36864
    ds_read_b64_tr_b16 v[44:45], v54 offset:24576
    ds_read_b64_tr_b16 v[46:47], v54 offset:26624
    ds_read_b64_tr_b16 v[48:49], v55 offset:24576
    ds_read_b64_tr_b16 v[50:51], v55 offset:26624
    s_waitcnt lgkmcnt(6)
    v_mfma_f32_32x32x16_bf16 v[64:79], v[20:23], v[36:39], v[64:79]
    v_mfma_f32_32x32x16_bf16 v[80:95], v[20:23], v[40:43], v[80:95]
    v_mfma_f32_32x32x16_bf16 v[96:111], v[24:27], v[36:39], v[96:111]
    v_mfma_f32_32x32x16_bf16 v[112:127], v[24:27], v[40:43], v[112:127]
    s_waitcnt lgkmcnt(0)
    s_waitcnt vmcnt(6)
    s_barrier
    s_add_u32 m0, s36, 32768
    s_nop 0
    buffer_load_dwordx4 v2, s[8:11], s34 offen lds
    s_add_u32 m0, s36, 33792
    s_nop 0
    buffer_load_dwordx4 v3, s[8:11], s34 offen lds
    s_add_u32 m0, s37, 65536
    s_nop 0
    buffer_load_dwordx4 v4, s[12:15], s35 offen lds
    s_add_u32 m0, s37, 66560
    s_nop 0
    buffer_load_dwordx4 v5, s[12:15], s35 offen lds
    s_add_u32 m0, s37, 67584
    s_nop 0
    buffer_load_dwordx4 v6, s[12:15], s35 offen lds
    s_add_u32 m0, s37, 68608
    s_nop 0
    buffer_load_dwordx4 v7, s[12:15], s35 offen lds
    s_add_u32 s34, s34, 128
    s_lshl_b32 s38, s33, 6
    s_add_u32 s35, s35, s38
    ds_read_b128 v[20:23], v8 offset:0
    ds_read_b128 v[24:27], v8 offset:4096
    ds_read_b64_tr_b16 v[36:37], v12 offset:0
    ds_read_b64_tr_b16 v[38:39], v12 offset:2048
    ds_read_b64_tr_b16 v[40:41], v13 offset:0
    ds_read_b64_tr_b16 v[42:43], v13 offset:2048
    v_mfma_f32_32x32x16_bf16 v[64:79], v[28:31], v[44:47], v[64:79]
    v_mfma_f32_32x32x16_bf16 v[80:95], v[28:31], v[48:51], v[80:95]
    v_mfma_f32_32x32x16_bf16 v[96:111], v[32:35], v[44:47], v[96:111]
    v_mfma_f32_32x32x16_bf16 v[112:127], v[32:35], v[48:51], v[112:127]
    ds_read_b128 v[28:31], v9 offset:0
    ds_read_b128 v[32:35], v9 offset:4096
    ds_read_b64_tr_b16 v[44:45], v12 offset:8192
    ds_read_b64_tr_b16 v[46:47], v12 offset:10240
    ds_read_b64_tr_b16 v[48:49], v13 offset:8192
    ds_read_b64_tr_b16 v[50:51], v13 offset:10240
    s_waitcnt lgkmcnt(6)
    v_mfma_f32_32x32x16_bf16 v[64:79], v[20:23], v[36:39], v[64:79]
    v_mfma_f32_32x32x16_bf16 v[80:95], v[20:23], v[40:43], v[80:95]
    v_mfma_f32_32x32x16_bf16 v[96:111], v[24:27], v[36:39], v[96:111]
    v_mfma_f32_32x32x16_bf16 v[112:127], v[24:27], v[40:43], v[112:127]
    ds_read_b128 v[20:23], v10 offset:0
    ds_read_b128 v[24:27], v10 offset:4096
    ds_read_b64_tr_b16 v[36:37], v12 offset:16384
    ds_read_b64_tr_b16 v[38:39], v12 offset:18432
    ds_read_b64_tr_b16 v[40:41], v13 offset:16384
    ds_read_b64_tr_b16 v[42:43], v13 offset:18432
    s_waitcnt lgkmcnt(6)
    v_mfma_f32_32x32x16_bf16 v[64:79], v[28:31], v[44:47], v[64:79]
    v_mfma_f32_32x32x16_bf16 v[80:95], v[28:31], v[48:51], v[80:95]
    v_mfma_f32_32x32x16_bf16 v[96:111], v[32:35], v[44:47], v[96:111]
    v_mfma_f32_32x32x16_bf16 v[112:127], v[32:35], v[48:51], v[112:127]
    ds_read_b128 v[28:31], v11 offset:0
    ds_read_b128 v[32:35], v11 offset:4096
    ds_read_b64_tr_b16 v[44:45], v12 offset:24576
    ds_read_b64_tr_b16 v[46:47], v12 offset:26624
    ds_read_b64_tr_b16 v[48:49], v13 offset:24576
    ds_read_b64_tr_b16 v[50:51], v13 offset:26624
    s_waitcnt lgkmcnt(6)
    v_mfma_f32_32x32x16_bf16 v[64:79], v[20:23], v[36:39], v[64:79]
    v_mfma_f32_32x32x16_bf16 v[80:95], v[20:23], v[40:43], v[80:95]
    v_mfma_f32_32x32x16_bf16 v[96:111], v[24:27], v[36:39], v[96:111]
    v_mfma_f32_32x32x16_bf16 v[112:127], v[24:27], v[40:43], v[112:127]
    s_waitcnt lgkmcnt(0)
    s_waitcnt vmcnt(6)
    s_barrier
    s_add_u32 m0, s36, 0
    s_nop 0
    buffer_load_dwordx4 v2, s[8:11], s34 offen lds
    s_add_u32 m0, s36, 1024
    s_nop 0
    buffer_load_dwordx4 v3, s[8:11], s34 offen lds
    s_add_u32 m0, s37, 0
    s_nop 0
    buffer_load_dwordx4 v4, s[12:15], s35 offen lds
    s_add_u32 m0, s37, 1024
    s_nop 0
    buffer_load_dwordx4 v5, s[12:15], s35 offen lds
    s_add_u32 m0, s37, 2048
    s_nop 0
    buffer_load_dwordx4 v6, s[12:15], s35 offen lds
    s_add_u32 m0, s37, 3072
    s_nop 0
    buffer_load_dwordx4 v7, s[12:15], s35 offen lds
    s_add_u32 s34, s34, 128
    s_lshl_b32 s38, s33, 6
    s_add_u32 s35, s35, s38
    ds_read_b128 v[20:23], v8 offset:16384
    ds_read_b128 v[24:27], v8 offset:20480
    ds_read_b64_tr_b16 v[36:37], v52 offset:0
    ds_read_b64_tr_b16 v[38:39], v52 offset:2048
    ds_read_b64_tr_b16 v[40:41], v53 offset:0
    ds_read_b64_tr_b16 v[42:43], v53 offset:2048
    v_mfma_f32_32x32x16_bf16 v[64:79], v[28:31], v[44:47], v[64:79]
    v_mfma_f32_32x32x16_bf16 v[80:95], v[28:31], v[48:51], v[80:95]
    v_mfma_f32_32x32x16_bf16 v[96:111], v[32:35], v[44:47], v[96:111]
    v_mfma_f32_32x32x16_bf16 v[112:127], v[32:35], v[48:51], v[112:127]
    ds_read_b128 v[28:31], v9 offset:16384
    ds_read_b128 v[32:35], v9 offset:20480
    ds_read_b64_tr_b16 v[44:45], v52 offset:8192
    ds_read_b64_tr_b16 v[46:47], v52 offset:10240
    ds_read_b64_tr_b16 v[48:49], v53 offset:8192
    ds_read_b64_tr_b16 v[50:51], v53 offset:10240
    s_waitcnt lgkmcnt(6)
    v_mfma_f32_32x32x16_bf16 v[64:79], v[20:23], v[36:39], v[64:79]
    v_mfma_f32_32x32x16_bf16 v[80:95], v[20:23], v[40:43], v[80:95]
    v_mfma_f32_32x32x16_bf16 v[96:111], v[24:27], v[36:39], v[96:111]
    v_mfma_f32_32x32x16_bf16 v[112:127], v[24:27], v[40:43], v[112:127]
    ds_read_b128 v[20:23], v10 offset:16384
    ds_read_b128 v[24:27], v10 offset:20480
    ds_read_b64_tr_b16 v[36:37], v52 offset:16384
    ds_read_b64_tr_b16 v[38:39], v52 offset:18432
    ds_read_b64_tr_b16 v[40:41], v53 offset:16384
    ds_read_b64_tr_b16 v[42:43], v53 offset:18432
    s_waitcnt lgkmcnt(6)
    v_mfma_f32_32x32x16_bf16 v[64:79], v[28:31], v[44:47], v[64:79]
    v_mfma_f32_32x32x16_bf16 v[80:95], v[28:31], v[48:51], v[80:95]
    v_mfma_f32_32x32x16_bf16 v[96:111], v[32:35], v[44:47], v[96:111]
    v_mfma_f32_32x32x16_bf16 v[112:127], v[32:35], v[48:51], v[112:127]
    ds_read_b128 v[28:31], v11 offset:16384
    ds_read_b128 v[32:35], v11 offset:20480
    ds_read_b64_tr_b16 v[44:45], v52 offset:24576
    ds_read_b64_tr_b16 v[46:47], v52 offset:26624
    ds_read_b64_tr_b16 v[48:49], v53 offset:24576
    ds_read_b64_tr_b16 v[50:51], v53 offset:26624
    s_waitcnt lgkmcnt(6)
    v_mfma_f32_32x32x16_bf16 v[64:79], v[20:23], v[36:39], v[64:79]
    v_mfma_f32_32x32x16_bf16 v[80:95], v[20:23], v[40:43], v[80:95]
    v_mfma_f32_32x32x16_bf16 v[96:111], v[24:27], v[36:39], v[96:111]
    v_mfma_f32_32x32x16_bf16 v[112:127], v[24:27], v[40:43], v[112:127]
    s_waitcnt lgkmcnt(0)
    s_waitcnt vmcnt(6)
    s_barrier
    s_add_u32 m0, s36, 16384
    s_nop 0
    buffer_load_dwordx4 v2, s[8:11], s34 offen lds
    s_add_u32 m0, s36, 17408
    s_nop 0
    buffer_load_dwordx4 v3, s[8:11], s34 offen lds
    s_add_u32 m0, s37, 32768
    s_nop 0
    buffer_load_dwordx4 v4, s[12:15], s35 offen lds
    s_add_u32 m0, s37, 33792
    s_nop 0
    buffer_load_dwordx4 v5, s[12:15], s35 offen lds
    s_add_u32 m0, s37, 34816
    s_nop 0
    buffer_load_dwordx4 v6, s[12:15], s35 offen lds
    s_add_u32 m0, s37, 35840
    s_nop 0
    buffer_load_dwordx4 v7, s[12:15], s35 offen lds
    s_add_u32 s34, s34, 128
    s_lshl_b32 s38, s33, 6
    s_add_u32 s35, s35, s38
    ds_read_b128 v[20:23], v8 offset:32768
    ds_read_b128 v[24:27], v8 offset:36864
    ds_read_b64_tr_b16 v[36:37], v54 offset:0
    ds_read_b64_tr_b16 v[38:39], v54 offset:2048
    ds_read_b64_tr_b16 v[40:41], v55 offset:0
    ds_read_b64_tr_b16 v[42:43], v55 offset:2048
    v_mfma_f32_32x32x16_bf16 v[64:79], v[28:31], v[44:47], v[64:79]
    v_mfma_f32_32x32x16_bf16 v[80:95], v[28:31], v[48:51], v[80:95]
    v_mfma_f32_32x32x16_bf16 v[96:111], v[32:35], v[44:47], v[96:111]
    v_mfma_f32_32x32x16_bf16 v[112:127], v[32:35], v[48:51], v[112:127]
    ds_read_b128 v[28:31], v9 offset:32768
    ds_read_b128 v[32:35], v9 offset:36864
    ds_read_b64_tr_b16 v[44:45], v54 offset:8192
    ds_read_b64_tr_b16 v[46:47], v54 offset:10240
    ds_read_b64_tr_b16 v[48:49], v55 offset:8192
    ds_read_b64_tr_b16 v[50:51], v55 offset:10240
    s_waitcnt lgkmcnt(6)
    v_mfma_f32_32x32x16_bf16 v[64:79], v[20:23], v[36:39], v[64:79]
    v_mfma_f32_32x32x16_bf16 v[80:95], v[20:23], v[40:43], v[80:95]
    v_mfma_f32_32x32x16_bf16 v[96:111], v[24:27], v[36:39], v[96:111]
    v_mfma_f32_32x32x16_bf16 v[112:127], v[24:27], v[40:43], v[112:127]
    ds_read_b128 v[20:23], v10 offset:32768
    ds_read_b128 v[24:27], v10 offset:36864
    ds_read_b64_tr_b16 v[36:37], v54 offset:16384
    ds_read_b64_tr_b16 v[38:39], v54 offset:18432
    ds_read_b64_tr_b16 v[40:41], v55 offset:16384
    ds_read_b64_tr_b16 v[42:43], v55 offset:18432
    s_waitcnt lgkmcnt(6)
    v_mfma_f32_32x32x16_bf16 v[64:79], v[28:31], v[44:47], v[64:79]
    v_mfma_f32_32x32x16_bf16 v[80:95], v[28:31], v[48:51], v[80:95]
    v_mfma_f32_32x32x16_bf16 v[96:111], v[32:35], v[44:47], v[96:111]
    v_mfma_f32_32x32x16_bf16 v[112:127], v[32:35], v[48:51], v[112:127]
    ds_read_b128 v[28:31], v11 offset:32768
    ds_read_b128 v[32:35], v11 offset:36864
    ds_read_b64_tr_b16 v[44:45], v54 offset:24576
    ds_read_b64_tr_b16 v[46:47], v54 offset:26624
    ds_read_b64_tr_b16 v[48:49], v55 offset:24576
    ds_read_b64_tr_b16 v[50:51], v55 offset:26624
    s_waitcnt lgkmcnt(6)
    v_mfma_f32_32x32x16_bf16 v[64:79], v[20:23], v[36:39], v[64:79]
    v_mfma_f32_32x32x16_bf16 v[80:95], v[20:23], v[40:43], v[80:95]
    v_mfma_f32_32x32x16_bf16 v[96:111], v[24:27], v[36:39], v[96:111]
    v_mfma_f32_32x32x16_bf16 v[112:127], v[24:27], v[40:43], v[112:127]
    s_waitcnt lgkmcnt(0)
    s_waitcnt vmcnt(6)
    s_barrier
    ds_read_b128 v[20:23], v8 offset:0
    ds_read_b128 v[24:27], v8 offset:4096
    ds_read_b64_tr_b16 v[36:37], v12 offset:0
    ds_read_b64_tr_b16 v[38:39], v12 offset:2048
    ds_read_b64_tr_b16 v[40:41], v13 offset:0
    ds_read_b64_tr_b16 v[42:43], v13 offset:2048
    v_mfma_f32_32x32x16_bf16 v[64:79], v[28:31], v[44:47], v[64:79]
    v_mfma_f32_32x32x16_bf16 v[80:95], v[28:31], v[48:51], v[80:95]
    v_mfma_f32_32x32x16_bf16 v[96:111], v[32:35], v[44:47], v[96:111]
    v_mfma_f32_32x32x16_bf16 v[112:127], v[32:35], v[48:51], v[112:127]
    ds_read_b128 v[28:31], v9 offset:0
    ds_read_b128 v[32:35], v9 offset:4096
    ds_read_b64_tr_b16 v[44:45], v12 offset:8192
    ds_read_b64_tr_b16 v[46:47], v12 offset:10240
    ds_read_b64_tr_b16 v[48:49], v13 offset:8192
    ds_read_b64_tr_b16 v[50:51], v13 offset:10240
    s_waitcnt lgkmcnt(6)
    v_mfma_f32_32x32x16_bf16 v[64:79], v[20:23], v[36:39], v[64:79]
    v_mfma_f32_32x32x16_bf16 v[80:95], v[20:23], v[40:43], v[80:95]
    v_mfma_f32_32x32x16_bf16 v[96:111], v[24:27], v[36:39], v[96:111]
    v_mfma_f32_32x32x16_bf16 v[112:127], v[24:27], v[40:43], v[112:127]
    ds_read_b128 v[20:23], v10 offset:0
    ds_read_b128 v[24:27], v10 offset:4096
    ds_read_b64_tr_b16 v[36:37], v12 offset:16384
    ds_read_b64_tr_b16 v[38:39], v12 offset:18432
    ds_read_b64_tr_b16 v[40:41], v13 offset:16384
    ds_read_b64_tr_b16 v[42:43], v13 offset:18432
    s_waitcnt lgkmcnt(6)
    v_mfma_f32_32x32x16_bf16 v[64:79], v[28:31], v[44:47], v[64:79]
    v_mfma_f32_32x32x16_bf16 v[80:95], v[28:31], v[48:51], v[80:95]
    v_mfma_f32_32x32x16_bf16 v[96:111], v[32:35], v[44:47], v[96:111]
    v_mfma_f32_32x32x16_bf16 v[112:127], v[32:35], v[48:51], v[112:127]
    ds_read_b128 v[28:31], v11 offset:0
    ds_read_b128 v[32:35], v11 offset:4096
    ds_read_b64_tr_b16 v[44:45], v12 offset:24576
    ds_read_b64_tr_b16 v[46:47], v12 offset:26624
    ds_read_b64_tr_b16 v[48:49], v13 offset:24576
    ds_read_b64_tr_b16 v[50:51], v13 offset:26624
    s_waitcnt lgkmcnt(6)
    v_mfma_f32_32x32x16_bf16 v[64:79], v[20:23], v[36:39], v[64:79]
    v_mfma_f32_32x32x16_bf16 v[80:95], v[20:23], v[40:43], v[80:95]
    v_mfma_f32_32x32x16_bf16 v[96:111], v[24:27], v[36:39], v[96:111]
    v_mfma_f32_32x32x16_bf16 v[112:127], v[24:27], v[40:43], v[112:127]
    s_waitcnt lgkmcnt(0)
    s_waitcnt vmcnt(0)
    s_barrier
    ds_read_b128 v[20:23], v8 offset:16384
    ds_read_b128 v[24:27], v8 offset:20480
    ds_read_b64_tr_b16 v[36:37], v52 offset:0
    ds_read_b64_tr_b16 v[38:39], v52 offset:2048
    ds_read_b64_tr_b16 v[40:41], v53 offset:0
    ds_read_b64_tr_b16 v[42:43], v53 offset:2048
    v_mfma_f32_32x32x16_bf16 v[64:79], v[28:31], v[44:47], v[64:79]
    v_mfma_f32_32x32x16_bf16 v[80:95], v[28:31], v[48:51], v[80:95]
    v_mfma_f32_32x32x16_bf16 v[96:111], v[32:35], v[44:47], v[96:111]
    v_mfma_f32_32x32x16_bf16 v[112:127], v[32:35], v[48:51], v[112:127]
    ds_read_b128 v[28:31], v9 offset:16384
    ds_read_b128 v[32:35], v9 offset:20480
    ds_read_b64_tr_b16 v[44:45], v52 offset:8192
    ds_read_b64_tr_b16 v[46:47], v52 offset:10240
    ds_read_b64_tr_b16 v[48:49], v53 offset:8192
    ds_read_b64_tr_b16 v[50:51], v53 offset:10240
    s_waitcnt lgkmcnt(6)
    v_mfma_f32_32x32x16_bf16 v[64:79], v[20:23], v[36:39], v[64:79]
    v_mfma_f32_32x32x16_bf16 v[80:95], v[20:23], v[40:43], v[80:95]
    v_mfma_f32_32x32x16_bf16 v[96:111], v[24:27], v[36:39], v[96:111]
    v_mfma_f32_32x32x16_bf16 v[112:127], v[24:27], v[40:43], v[112:127]
    ds_read_b128 v[20:23], v10 offset:16384
    ds_read_b128 v[24:27], v10 offset:20480
    ds_read_b64_tr_b16 v[36:37], v52 offset:16384
    ds_read_b64_tr_b16 v[38:39], v52 offset:18432
    ds_read_b64_tr_b16 v[40:41], v53 offset:16384
    ds_read_b64_tr_b16 v[42:43], v53 offset:18432
    s_waitcnt lgkmcnt(6)
    v_mfma_f32_32x32x16_bf16 v[64:79], v[28:31], v[44:47], v[64:79]
    v_mfma_f32_32x32x16_bf16 v[80:95], v[28:31], v[48:51], v[80:95]
    v_mfma_f32_32x32x16_bf16 v[96:111], v[32:35], v[44:47], v[96:111]
    v_mfma_f32_32x32x16_bf16 v[112:127], v[32:35], v[48:51], v[112:127]
    ds_read_b128 v[28:31], v11 offset:16384
    ds_read_b128 v[32:35], v11 offset:20480
    ds_read_b64_tr_b16 v[44:45], v52 offset:24576
    ds_read_b64_tr_b16 v[46:47], v52 offset:26624
    ds_read_b64_tr_b16 v[48:49], v53 offset:24576
    ds_read_b64_tr_b16 v[50:51], v53 offset:26624
    s_waitcnt lgkmcnt(6)
    v_mfma_f32_32x32x16_bf16 v[64:79], v[20:23], v[36:39], v[64:79]
    v_mfma_f32_32x32x16_bf16 v[80:95], v[20:23], v[40:43], v[80:95]
    v_mfma_f32_32x32x16_bf16 v[96:111], v[24:27], v[36:39], v[96:111]
    v_mfma_f32_32x32x16_bf16 v[112:127], v[24:27], v[40:43], v[112:127]
    s_waitcnt lgkmcnt(0)
    v_mfma_f32_32x32x16_bf16 v[64:79], v[28:31], v[44:47], v[64:79]
    v_mfma_f32_32x32x16_bf16 v[80:95], v[28:31], v[48:51], v[80:95]
    v_mfma_f32_32x32x16_bf16 v[96:111], v[32:35], v[44:47], v[96:111]
    v_mfma_f32_32x32x16_bf16 v[112:127], v[32:35], v[48:51], v[112:127]
    s_nop 15
    s_nop 3
    s_sub_u32 s38, s32, 4
    s_lshl_b32 s38, s38, 4
    s_lshl_b32 s39, s42, 2
    s_add_u32 s38, s38, s39
    s_lshl_b32 s38, s38, 17
    s_lshl_b32 s39, s31, 2
    s_lshl_b32 s40, s41, 1
    s_add_u32 s39, s39, s40
    s_lshl_b32 s39, s39, 11
    s_add_u32 s45, s38, s39
    s_add_u32 s45, s45, 2098176
    v_lshrrev_b32 v14, 4, v1
    v_and_b32 v14, 1, v14
    v_lshlrev_b32 v14, 17, v14
    v_lshrrev_b32 v15, 5, v1
    v_lshl_add_u32 v14, v15, 8, v14
    v_and_b32 v15, 15, v1
    v_lshl_add_u32 v14, v15, 4, v14
    v_cvt_pk_bf16_f32 v128, v64, v65
    v_cvt_pk_bf16_f32 v129, v66, v67
    v_cvt_pk_bf16_f32 v130, v68, v69
    v_cvt_pk_bf16_f32 v131, v70, v71
    s_add_u32 s38, s45, 0
    buffer_store_dwordx4 v[128:131], v14, s[16:19], s38 offen
    v_cvt_pk_bf16_f32 v132, v72, v73
    v_cvt_pk_bf16_f32 v133, v74, v75
    v_cvt_pk_bf16_f32 v134, v76, v77
    v_cvt_pk_bf16_f32 v135, v78, v79
    s_add_u32 s38, s45, 512
    buffer_store_dwordx4 v[132:135], v14, s[16:19], s38 offen
    v_cvt_pk_bf16_f32 v136, v80, v81
    v_cvt_pk_bf16_f32 v137, v82, v83
    v_cvt_pk_bf16_f32 v138, v84, v85
    v_cvt_pk_bf16_f32 v139, v86, v87
    s_add_u32 s38, s45, 262144
    buffer_store_dwordx4 v[136:139], v14, s[16:19], s38 offen
    v_cvt_pk_bf16_f32 v140, v88, v89
    v_cvt_pk_bf16_f32 v141, v90, v91
    v_cvt_pk_bf16_f32 v142, v92, v93
    v_cvt_pk_bf16_f32 v143, v94, v95
    s_add_u32 s38, s45, 262656
    buffer_store_dwordx4 v[140:143], v14, s[16:19], s38 offen
    v_cvt_pk_bf16_f32 v144, v96, v97
    v_cvt_pk_bf16_f32 v145, v98, v99
    v_cvt_pk_bf16_f32 v146, v100, v101
    v_cvt_pk_bf16_f32 v147, v102, v103
    s_add_u32 s38, s45, 2048
    buffer_store_dwordx4 v[144:147], v14, s[16:19], s38 offen
    v_cvt_pk_bf16_f32 v148, v104, v105
    v_cvt_pk_bf16_f32 v149, v106, v107
    v_cvt_pk_bf16_f32 v150, v108, v109
    v_cvt_pk_bf16_f32 v151, v110, v111
    s_add_u32 s38, s45, 2560
    buffer_store_dwordx4 v[148:151], v14, s[16:19], s38 offen
    v_cvt_pk_bf16_f32 v152, v112, v113
    v_cvt_pk_bf16_f32 v153, v114, v115
    v_cvt_pk_bf16_f32 v154, v116, v117
    v_cvt_pk_bf16_f32 v155, v118, v119
    s_add_u32 s38, s45, 264192
    buffer_store_dwordx4 v[152:155], v14, s[16:19], s38 offen
    v_cvt_pk_bf16_f32 v156, v120, v121
    v_cvt_pk_bf16_f32 v157, v122, v123
    v_cvt_pk_bf16_f32 v158, v124, v125
    v_cvt_pk_bf16_f32 v159, v126, v127
    s_add_u32 s38, s45, 264704
    buffer_store_dwordx4 v[156:159], v14, s[16:19], s38 offen
    s_waitcnt vmcnt(0)
    s_endpgm
k1_kernel_aux:
    s_load_dwordx2 s[46:47], s[0:1], 64
    s_load_dwordx2 s[48:49], s[0:1], 48
    s_load_dwordx2 s[50:51], s[0:1], 16
    s_sub_u32 s31, s2, 208
    s_lshl_b32 s31, s31, 3
    s_add_u32 s31, s31, s30
    s_mov_b32 s8, s4
    s_and_b32 s9, s5, 0xffff
    s_mov_b32 s10, 2097152
    s_mov_b32 s11, 0x20000
    s_mov_b32 s16, s28
    s_and_b32 s17, s29, 0xffff
    s_mov_b32 s18, 23068672
    s_mov_b32 s19, 0x20000
    s_waitcnt lgkmcnt(0)
    s_mov_b32 s12, s46
    s_and_b32 s13, s47, 0xffff
    s_mov_b32 s14, 1024
    s_mov_b32 s15, 0x20000
    s_cmp_lt_u32 s31, 224
    s_cbranch_scc1 k1_kernel_aux_w2
    s_mov_b32 s20, s50
    s_and_b32 s21, s51, 0xffff
    s_mov_b32 s22, 524288
    s_sub_u32 s34, s31, 224
    s_lshl_b32 s34, s34, 4
    s_mov_b32 s35, 32
    s_mov_b32 s36, 134217728
    s_mov_b32 s37, 2
    s_mov_b32 s43, 1792
    s_branch k1_kernel_aux_wsel
k1_kernel_aux_w2:
    s_mov_b32 s20, s48
    s_and_b32 s21, s49, 0xffff
    s_mov_b32 s22, 1835008
    s_lshl_b32 s34, s31, 3
    s_mov_b32 s35, 112
    s_mov_b32 s36, 38347923
    s_mov_b32 s37, 1
    s_mov_b32 s43, 0
k1_kernel_aux_wsel:
    s_mov_b32 s23, 0x20000
    v_lshrrev_b32 v2, 5, v1
    v_lshlrev_b32 v2, 12, v2
    v_and_b32 v3, 31, v1
    v_lshl_add_u32 v2, v3, 1, v2
    v_add_u32 v3, 8192, v2
    v_lshlrev_b32 v4, 4, v1
k1_kernel_aux_batch:
    s_add_u32 s38, s34, 0
    s_mul_hi_u32 s39, s38, s36
    s_mul_i32 s33, s39, s35
    s_sub_u32 s33, s38, s33
    s_lshl_b32 s33, s33, 14
    s_lshl_b32 s39, s39, 6
    s_add_u32 s33, s33, s39
    buffer_load_ushort v64, v2, s[20:23], s33 offen offset:0
    buffer_load_ushort v68, v2, s[20:23], s33 offen offset:1024
    buffer_load_ushort v65, v2, s[20:23], s33 offen offset:2048
    buffer_load_ushort v69, v2, s[20:23], s33 offen offset:3072
    buffer_load_ushort v66, v3, s[20:23], s33 offen offset:0
    buffer_load_ushort v70, v3, s[20:23], s33 offen offset:1024
    buffer_load_ushort v67, v3, s[20:23], s33 offen offset:2048
    buffer_load_ushort v71, v3, s[20:23], s33 offen offset:3072
    s_add_u32 s38, s34, 1
    s_mul_hi_u32 s39, s38, s36
    s_mul_i32 s33, s39, s35
    s_sub_u32 s33, s38, s33
    s_lshl_b32 s33, s33, 14
    s_lshl_b32 s39, s39, 6
    s_add_u32 s33, s33, s39
    buffer_load_ushort v72, v2, s[20:23], s33 offen offset:0
    buffer_load_ushort v76, v2, s[20:23], s33 offen offset:1024
    buffer_load_ushort v73, v2, s[20:23], s33 offen offset:2048
    buffer_load_ushort v77, v2, s[20:23], s33 offen offset:3072
    buffer_load_ushort v74, v3, s[20:23], s33 offen offset:0
    buffer_load_ushort v78, v3, s[20:23], s33 offen offset:1024
    buffer_load_ushort v75, v3, s[20:23], s33 offen offset:2048
    buffer_load_ushort v79, v3, s[20:23], s33 offen offset:3072
    s_add_u32 s38, s34, 2
    s_mul_hi_u32 s39, s38, s36
    s_mul_i32 s33, s39, s35
    s_sub_u32 s33, s38, s33
    s_lshl_b32 s33, s33, 14
    s_lshl_b32 s39, s39, 6
    s_add_u32 s33, s33, s39
    buffer_load_ushort v80, v2, s[20:23], s33 offen offset:0
    buffer_load_ushort v84, v2, s[20:23], s33 offen offset:1024
    buffer_load_ushort v81, v2, s[20:23], s33 offen offset:2048
    buffer_load_ushort v85, v2, s[20:23], s33 offen offset:3072
    buffer_load_ushort v82, v3, s[20:23], s33 offen offset:0
    buffer_load_ushort v86, v3, s[20:23], s33 offen offset:1024
    buffer_load_ushort v83, v3, s[20:23], s33 offen offset:2048
    buffer_load_ushort v87, v3, s[20:23], s33 offen offset:3072
    s_add_u32 s38, s34, 3
    s_mul_hi_u32 s39, s38, s36
    s_mul_i32 s33, s39, s35
    s_sub_u32 s33, s38, s33
    s_lshl_b32 s33, s33, 14
    s_lshl_b32 s39, s39, 6
    s_add_u32 s33, s33, s39
    buffer_load_ushort v88, v2, s[20:23], s33 offen offset:0
    buffer_load_ushort v92, v2, s[20:23], s33 offen offset:1024
    buffer_load_ushort v89, v2, s[20:23], s33 offen offset:2048
    buffer_load_ushort v93, v2, s[20:23], s33 offen offset:3072
    buffer_load_ushort v90, v3, s[20:23], s33 offen offset:0
    buffer_load_ushort v94, v3, s[20:23], s33 offen offset:1024
    buffer_load_ushort v91, v3, s[20:23], s33 offen offset:2048
    buffer_load_ushort v95, v3, s[20:23], s33 offen offset:3072
    s_add_u32 s38, s34, 4
    s_mul_hi_u32 s39, s38, s36
    s_mul_i32 s33, s39, s35
    s_sub_u32 s33, s38, s33
    s_lshl_b32 s33, s33, 14
    s_lshl_b32 s39, s39, 6
    s_add_u32 s33, s33, s39
    buffer_load_ushort v96, v2, s[20:23], s33 offen offset:0
    buffer_load_ushort v100, v2, s[20:23], s33 offen offset:1024
    buffer_load_ushort v97, v2, s[20:23], s33 offen offset:2048
    buffer_load_ushort v101, v2, s[20:23], s33 offen offset:3072
    buffer_load_ushort v98, v3, s[20:23], s33 offen offset:0
    buffer_load_ushort v102, v3, s[20:23], s33 offen offset:1024
    buffer_load_ushort v99, v3, s[20:23], s33 offen offset:2048
    buffer_load_ushort v103, v3, s[20:23], s33 offen offset:3072
    s_add_u32 s38, s34, 5
    s_mul_hi_u32 s39, s38, s36
    s_mul_i32 s33, s39, s35
    s_sub_u32 s33, s38, s33
    s_lshl_b32 s33, s33, 14
    s_lshl_b32 s39, s39, 6
    s_add_u32 s33, s33, s39
    buffer_load_ushort v104, v2, s[20:23], s33 offen offset:0
    buffer_load_ushort v108, v2, s[20:23], s33 offen offset:1024
    buffer_load_ushort v105, v2, s[20:23], s33 offen offset:2048
    buffer_load_ushort v109, v2, s[20:23], s33 offen offset:3072
    buffer_load_ushort v106, v3, s[20:23], s33 offen offset:0
    buffer_load_ushort v110, v3, s[20:23], s33 offen offset:1024
    buffer_load_ushort v107, v3, s[20:23], s33 offen offset:2048
    buffer_load_ushort v111, v3, s[20:23], s33 offen offset:3072
    s_add_u32 s38, s34, 6
    s_mul_hi_u32 s39, s38, s36
    s_mul_i32 s33, s39, s35
    s_sub_u32 s33, s38, s33
    s_lshl_b32 s33, s33, 14
    s_lshl_b32 s39, s39, 6
    s_add_u32 s33, s33, s39
    buffer_load_ushort v112, v2, s[20:23], s33 offen offset:0
    buffer_load_ushort v116, v2, s[20:23], s33 offen offset:1024
    buffer_load_ushort v113, v2, s[20:23], s33 offen offset:2048
    buffer_load_ushort v117, v2, s[20:23], s33 offen offset:3072
    buffer_load_ushort v114, v3, s[20:23], s33 offen offset:0
    buffer_load_ushort v118, v3, s[20:23], s33 offen offset:1024
    buffer_load_ushort v115, v3, s[20:23], s33 offen offset:2048
    buffer_load_ushort v119, v3, s[20:23], s33 offen offset:3072
    s_add_u32 s38, s34, 7
    s_mul_hi_u32 s39, s38, s36
    s_mul_i32 s33, s39, s35
    s_sub_u32 s33, s38, s33
    s_lshl_b32 s33, s33, 14
    s_lshl_b32 s39, s39, 6
    s_add_u32 s33, s33, s39
    buffer_load_ushort v120, v2, s[20:23], s33 offen offset:0
    buffer_load_ushort v124, v2, s[20:23], s33 offen offset:1024
    buffer_load_ushort v121, v2, s[20:23], s33 offen offset:2048
    buffer_load_ushort v125, v2, s[20:23], s33 offen offset:3072
    buffer_load_ushort v122, v3, s[20:23], s33 offen offset:0
    buffer_load_ushort v126, v3, s[20:23], s33 offen offset:1024
    buffer_load_ushort v123, v3, s[20:23], s33 offen offset:2048
    buffer_load_ushort v127, v3, s[20:23], s33 offen offset:3072
    s_waitcnt vmcnt(0)
    v_lshl_or_b32 v64, v68, 16, v64
    v_lshl_or_b32 v65, v69, 16, v65
    v_lshl_or_b32 v66, v70, 16, v66
    v_lshl_or_b32 v67, v71, 16, v67
    v_lshl_or_b32 v72, v76, 16, v72
    v_lshl_or_b32 v73, v77, 16, v73
    v_lshl_or_b32 v74, v78, 16, v74
    v_lshl_or_b32 v75, v79, 16, v75
    v_lshl_or_b32 v80, v84, 16, v80
    v_lshl_or_b32 v81, v85, 16, v81
    v_lshl_or_b32 v82, v86, 16, v82
    v_lshl_or_b32 v83, v87, 16, v83
    v_lshl_or_b32 v88, v92, 16, v88
    v_lshl_or_b32 v89, v93, 16, v89
    v_lshl_or_b32 v90, v94, 16, v90
    v_lshl_or_b32 v91, v95, 16, v91
    v_lshl_or_b32 v96, v100, 16, v96
    v_lshl_or_b32 v97, v101, 16, v97
    v_lshl_or_b32 v98, v102, 16, v98
    v_lshl_or_b32 v99, v103, 16, v99
    v_lshl_or_b32 v104, v108, 16, v104
    v_lshl_or_b32 v105, v109, 16, v105
    v_lshl_or_b32 v106, v110, 16, v106
    v_lshl_or_b32 v107, v111, 16, v107
    v_lshl_or_b32 v112, v116, 16, v112
    v_lshl_or_b32 v113, v117, 16, v113
    v_lshl_or_b32 v114, v118, 16, v114
    v_lshl_or_b32 v115, v119, 16, v115
    v_lshl_or_b32 v120, v124, 16, v120
    v_lshl_or_b32 v121, v125, 16, v121
    v_lshl_or_b32 v122, v126, 16, v122
    v_lshl_or_b32 v123, v127, 16, v123
    s_add_u32 s38, s34, s43
    s_add_u32 s38, s38, 0
    s_lshl_b32 s38, s38, 10
    s_add_u32 s38, s38, 13631488
    buffer_store_dwordx4 v[64:67], v4, s[16:19], s38 offen
    s_add_u32 s38, s34, s43
    s_add_u32 s38, s38, 1
    s_lshl_b32 s38, s38, 10
    s_add_u32 s38, s38, 13631488
    buffer_store_dwordx4 v[72:75], v4, s[16:19], s38 offen
    s_add_u32 s38, s34, s43
    s_add_u32 s38, s38, 2
    s_lshl_b32 s38, s38, 10
    s_add_u32 s38, s38, 13631488
    buffer_store_dwordx4 v[80:83], v4, s[16:19], s38 offen
    s_add_u32 s38, s34, s43
    s_add_u32 s38, s38, 3
    s_lshl_b32 s38, s38, 10
    s_add_u32 s38, s38, 13631488
    buffer_store_dwordx4 v[88:91], v4, s[16:19], s38 offen
    s_add_u32 s38, s34, s43
    s_add_u32 s38, s38, 4
    s_lshl_b32 s38, s38, 10
    s_add_u32 s38, s38, 13631488
    buffer_store_dwordx4 v[96:99], v4, s[16:19], s38 offen
    s_add_u32 s38, s34, s43
    s_add_u32 s38, s38, 5
    s_lshl_b32 s38, s38, 10
    s_add_u32 s38, s38, 13631488
    buffer_store_dwordx4 v[104:107], v4, s[16:19], s38 offen
    s_add_u32 s38, s34, s43
    s_add_u32 s38, s38, 6
    s_lshl_b32 s38, s38, 10
    s_add_u32 s38, s38, 13631488
    buffer_store_dwordx4 v[112:115], v4, s[16:19], s38 offen
    s_add_u32 s38, s34, s43
    s_add_u32 s38, s38, 7
    s_lshl_b32 s38, s38, 10
    s_add_u32 s38, s38, 13631488
    buffer_store_dwordx4 v[120:123], v4, s[16:19], s38 offen
    s_add_u32 s34, s34, 8
    s_sub_u32 s37, s37, 1
    s_cmp_lg_u32 s37, 0
    s_waitcnt vmcnt(0)
    s_cbranch_scc1 k1_kernel_aux_batch
    buffer_load_dwordx4 v[8:11], v4, s[12:15], 0 offen
    s_lshl_b32 s32, s31, 13
    s_add_u32 s38, s32, 4096
    buffer_load_dwordx4 v[32:35], v4, s[8:11], s32 offen offset:0
    buffer_load_dwordx4 v[36:39], v4, s[8:11], s32 offen offset:1024
    buffer_load_dwordx4 v[40:43], v4, s[8:11], s32 offen offset:2048
    buffer_load_dwordx4 v[44:47], v4, s[8:11], s32 offen offset:3072
    buffer_load_dwordx4 v[48:51], v4, s[8:11], s38 offen offset:0
    buffer_load_dwordx4 v[52:55], v4, s[8:11], s38 offen offset:1024
    buffer_load_dwordx4 v[56:59], v4, s[8:11], s38 offen offset:2048
    buffer_load_dwordx4 v[60:63], v4, s[8:11], s38 offen offset:3072
    s_waitcnt vmcnt(0)
    v_lshlrev_b32 v12, 16, v8
    v_and_b32 v13, 0xffff0000, v8
    v_lshlrev_b32 v14, 16, v9
    v_and_b32 v15, 0xffff0000, v9
    v_lshlrev_b32 v16, 16, v10
    v_and_b32 v17, 0xffff0000, v10
    v_lshlrev_b32 v18, 16, v11
    v_and_b32 v19, 0xffff0000, v11
    v_mov_b32 v20, 0
    v_lshlrev_b32 v5, 16, v32
    v_and_b32 v6, 0xffff0000, v32
    v_mul_f32 v5, v5, v12
    v_mul_f32 v6, v6, v13
    v_cvt_pk_bf16_f32 v7, v5, v6
    v_lshlrev_b32 v5, 16, v7
    v_and_b32 v6, 0xffff0000, v7
    v_add_f32 v20, v20, v5
    v_add_f32 v20, v20, v6
    v_lshlrev_b32 v5, 16, v33
    v_and_b32 v6, 0xffff0000, v33
    v_mul_f32 v5, v5, v14
    v_mul_f32 v6, v6, v15
    v_cvt_pk_bf16_f32 v7, v5, v6
    v_lshlrev_b32 v5, 16, v7
    v_and_b32 v6, 0xffff0000, v7
    v_add_f32 v20, v20, v5
    v_add_f32 v20, v20, v6
    v_lshlrev_b32 v5, 16, v34
    v_and_b32 v6, 0xffff0000, v34
    v_mul_f32 v5, v5, v16
    v_mul_f32 v6, v6, v17
    v_cvt_pk_bf16_f32 v7, v5, v6
    v_lshlrev_b32 v5, 16, v7
    v_and_b32 v6, 0xffff0000, v7
    v_add_f32 v20, v20, v5
    v_add_f32 v20, v20, v6
    v_lshlrev_b32 v5, 16, v35
    v_and_b32 v6, 0xffff0000, v35
    v_mul_f32 v5, v5, v18
    v_mul_f32 v6, v6, v19
    v_cvt_pk_bf16_f32 v7, v5, v6
    v_lshlrev_b32 v5, 16, v7
    v_and_b32 v6, 0xffff0000, v7
    v_add_f32 v20, v20, v5
    v_add_f32 v20, v20, v6
    v_mov_b32 v21, 0
    v_lshlrev_b32 v5, 16, v36
    v_and_b32 v6, 0xffff0000, v36
    v_mul_f32 v5, v5, v12
    v_mul_f32 v6, v6, v13
    v_cvt_pk_bf16_f32 v7, v5, v6
    v_lshlrev_b32 v5, 16, v7
    v_and_b32 v6, 0xffff0000, v7
    v_add_f32 v21, v21, v5
    v_add_f32 v21, v21, v6
    v_lshlrev_b32 v5, 16, v37
    v_and_b32 v6, 0xffff0000, v37
    v_mul_f32 v5, v5, v14
    v_mul_f32 v6, v6, v15
    v_cvt_pk_bf16_f32 v7, v5, v6
    v_lshlrev_b32 v5, 16, v7
    v_and_b32 v6, 0xffff0000, v7
    v_add_f32 v21, v21, v5
    v_add_f32 v21, v21, v6
    v_lshlrev_b32 v5, 16, v38
    v_and_b32 v6, 0xffff0000, v38
    v_mul_f32 v5, v5, v16
    v_mul_f32 v6, v6, v17
    v_cvt_pk_bf16_f32 v7, v5, v6
    v_lshlrev_b32 v5, 16, v7
    v_and_b32 v6, 0xffff0000, v7
    v_add_f32 v21, v21, v5
    v_add_f32 v21, v21, v6
    v_lshlrev_b32 v5, 16, v39
    v_and_b32 v6, 0xffff0000, v39
    v_mul_f32 v5, v5, v18
    v_mul_f32 v6, v6, v19
    v_cvt_pk_bf16_f32 v7, v5, v6
    v_lshlrev_b32 v5, 16, v7
    v_and_b32 v6, 0xffff0000, v7
    v_add_f32 v21, v21, v5
    v_add_f32 v21, v21, v6
    v_mov_b32 v22, 0
    v_lshlrev_b32 v5, 16, v40
    v_and_b32 v6, 0xffff0000, v40
    v_mul_f32 v5, v5, v12
    v_mul_f32 v6, v6, v13
    v_cvt_pk_bf16_f32 v7, v5, v6
    v_lshlrev_b32 v5, 16, v7
    v_and_b32 v6, 0xffff0000, v7
    v_add_f32 v22, v22, v5
    v_add_f32 v22, v22, v6
    v_lshlrev_b32 v5, 16, v41
    v_and_b32 v6, 0xffff0000, v41
    v_mul_f32 v5, v5, v14
    v_mul_f32 v6, v6, v15
    v_cvt_pk_bf16_f32 v7, v5, v6
    v_lshlrev_b32 v5, 16, v7
    v_and_b32 v6, 0xffff0000, v7
    v_add_f32 v22, v22, v5
    v_add_f32 v22, v22, v6
    v_lshlrev_b32 v5, 16, v42
    v_and_b32 v6, 0xffff0000, v42
    v_mul_f32 v5, v5, v16
    v_mul_f32 v6, v6, v17
    v_cvt_pk_bf16_f32 v7, v5, v6
    v_lshlrev_b32 v5, 16, v7
    v_and_b32 v6, 0xffff0000, v7
    v_add_f32 v22, v22, v5
    v_add_f32 v22, v22, v6
    v_lshlrev_b32 v5, 16, v43
    v_and_b32 v6, 0xffff0000, v43
    v_mul_f32 v5, v5, v18
    v_mul_f32 v6, v6, v19
    v_cvt_pk_bf16_f32 v7, v5, v6
    v_lshlrev_b32 v5, 16, v7
    v_and_b32 v6, 0xffff0000, v7
    v_add_f32 v22, v22, v5
    v_add_f32 v22, v22, v6
    v_mov_b32 v23, 0
    v_lshlrev_b32 v5, 16, v44
    v_and_b32 v6, 0xffff0000, v44
    v_mul_f32 v5, v5, v12
    v_mul_f32 v6, v6, v13
    v_cvt_pk_bf16_f32 v7, v5, v6
    v_lshlrev_b32 v5, 16, v7
    v_and_b32 v6, 0xffff0000, v7
    v_add_f32 v23, v23, v5
    v_add_f32 v23, v23, v6
    v_lshlrev_b32 v5, 16, v45
    v_and_b32 v6, 0xffff0000, v45
    v_mul_f32 v5, v5, v14
    v_mul_f32 v6, v6, v15
    v_cvt_pk_bf16_f32 v7, v5, v6
    v_lshlrev_b32 v5, 16, v7
    v_and_b32 v6, 0xffff0000, v7
    v_add_f32 v23, v23, v5
    v_add_f32 v23, v23, v6
    v_lshlrev_b32 v5, 16, v46
    v_and_b32 v6, 0xffff0000, v46
    v_mul_f32 v5, v5, v16
    v_mul_f32 v6, v6, v17
    v_cvt_pk_bf16_f32 v7, v5, v6
    v_lshlrev_b32 v5, 16, v7
    v_and_b32 v6, 0xffff0000, v7
    v_add_f32 v23, v23, v5
    v_add_f32 v23, v23, v6
    v_lshlrev_b32 v5, 16, v47
    v_and_b32 v6, 0xffff0000, v47
    v_mul_f32 v5, v5, v18
    v_mul_f32 v6, v6, v19
    v_cvt_pk_bf16_f32 v7, v5, v6
    v_lshlrev_b32 v5, 16, v7
    v_and_b32 v6, 0xffff0000, v7
    v_add_f32 v23, v23, v5
    v_add_f32 v23, v23, v6
    v_mov_b32 v24, 0
    v_lshlrev_b32 v5, 16, v48
    v_and_b32 v6, 0xffff0000, v48
    v_mul_f32 v5, v5, v12
    v_mul_f32 v6, v6, v13
    v_cvt_pk_bf16_f32 v7, v5, v6
    v_lshlrev_b32 v5, 16, v7
    v_and_b32 v6, 0xffff0000, v7
    v_add_f32 v24, v24, v5
    v_add_f32 v24, v24, v6
    v_lshlrev_b32 v5, 16, v49
    v_and_b32 v6, 0xffff0000, v49
    v_mul_f32 v5, v5, v14
    v_mul_f32 v6, v6, v15
    v_cvt_pk_bf16_f32 v7, v5, v6
    v_lshlrev_b32 v5, 16, v7
    v_and_b32 v6, 0xffff0000, v7
    v_add_f32 v24, v24, v5
    v_add_f32 v24, v24, v6
    v_lshlrev_b32 v5, 16, v50
    v_and_b32 v6, 0xffff0000, v50
    v_mul_f32 v5, v5, v16
    v_mul_f32 v6, v6, v17
    v_cvt_pk_bf16_f32 v7, v5, v6
    v_lshlrev_b32 v5, 16, v7
    v_and_b32 v6, 0xffff0000, v7
    v_add_f32 v24, v24, v5
    v_add_f32 v24, v24, v6
    v_lshlrev_b32 v5, 16, v51
    v_and_b32 v6, 0xffff0000, v51
    v_mul_f32 v5, v5, v18
    v_mul_f32 v6, v6, v19
    v_cvt_pk_bf16_f32 v7, v5, v6
    v_lshlrev_b32 v5, 16, v7
    v_and_b32 v6, 0xffff0000, v7
    v_add_f32 v24, v24, v5
    v_add_f32 v24, v24, v6
    v_mov_b32 v25, 0
    v_lshlrev_b32 v5, 16, v52
    v_and_b32 v6, 0xffff0000, v52
    v_mul_f32 v5, v5, v12
    v_mul_f32 v6, v6, v13
    v_cvt_pk_bf16_f32 v7, v5, v6
    v_lshlrev_b32 v5, 16, v7
    v_and_b32 v6, 0xffff0000, v7
    v_add_f32 v25, v25, v5
    v_add_f32 v25, v25, v6
    v_lshlrev_b32 v5, 16, v53
    v_and_b32 v6, 0xffff0000, v53
    v_mul_f32 v5, v5, v14
    v_mul_f32 v6, v6, v15
    v_cvt_pk_bf16_f32 v7, v5, v6
    v_lshlrev_b32 v5, 16, v7
    v_and_b32 v6, 0xffff0000, v7
    v_add_f32 v25, v25, v5
    v_add_f32 v25, v25, v6
    v_lshlrev_b32 v5, 16, v54
    v_and_b32 v6, 0xffff0000, v54
    v_mul_f32 v5, v5, v16
    v_mul_f32 v6, v6, v17
    v_cvt_pk_bf16_f32 v7, v5, v6
    v_lshlrev_b32 v5, 16, v7
    v_and_b32 v6, 0xffff0000, v7
    v_add_f32 v25, v25, v5
    v_add_f32 v25, v25, v6
    v_lshlrev_b32 v5, 16, v55
    v_and_b32 v6, 0xffff0000, v55
    v_mul_f32 v5, v5, v18
    v_mul_f32 v6, v6, v19
    v_cvt_pk_bf16_f32 v7, v5, v6
    v_lshlrev_b32 v5, 16, v7
    v_and_b32 v6, 0xffff0000, v7
    v_add_f32 v25, v25, v5
    v_add_f32 v25, v25, v6
    v_mov_b32 v26, 0
    v_lshlrev_b32 v5, 16, v56
    v_and_b32 v6, 0xffff0000, v56
    v_mul_f32 v5, v5, v12
    v_mul_f32 v6, v6, v13
    v_cvt_pk_bf16_f32 v7, v5, v6
    v_lshlrev_b32 v5, 16, v7
    v_and_b32 v6, 0xffff0000, v7
    v_add_f32 v26, v26, v5
    v_add_f32 v26, v26, v6
    v_lshlrev_b32 v5, 16, v57
    v_and_b32 v6, 0xffff0000, v57
    v_mul_f32 v5, v5, v14
    v_mul_f32 v6, v6, v15
    v_cvt_pk_bf16_f32 v7, v5, v6
    v_lshlrev_b32 v5, 16, v7
    v_and_b32 v6, 0xffff0000, v7
    v_add_f32 v26, v26, v5
    v_add_f32 v26, v26, v6
    v_lshlrev_b32 v5, 16, v58
    v_and_b32 v6, 0xffff0000, v58
    v_mul_f32 v5, v5, v16
    v_mul_f32 v6, v6, v17
    v_cvt_pk_bf16_f32 v7, v5, v6
    v_lshlrev_b32 v5, 16, v7
    v_and_b32 v6, 0xffff0000, v7
    v_add_f32 v26, v26, v5
    v_add_f32 v26, v26, v6
    v_lshlrev_b32 v5, 16, v59
    v_and_b32 v6, 0xffff0000, v59
    v_mul_f32 v5, v5, v18
    v_mul_f32 v6, v6, v19
    v_cvt_pk_bf16_f32 v7, v5, v6
    v_lshlrev_b32 v5, 16, v7
    v_and_b32 v6, 0xffff0000, v7
    v_add_f32 v26, v26, v5
    v_add_f32 v26, v26, v6
    v_mov_b32 v27, 0
    v_lshlrev_b32 v5, 16, v60
    v_and_b32 v6, 0xffff0000, v60
    v_mul_f32 v5, v5, v12
    v_mul_f32 v6, v6, v13
    v_cvt_pk_bf16_f32 v7, v5, v6
    v_lshlrev_b32 v5, 16, v7
    v_and_b32 v6, 0xffff0000, v7
    v_add_f32 v27, v27, v5
    v_add_f32 v27, v27, v6
    v_lshlrev_b32 v5, 16, v61
    v_and_b32 v6, 0xffff0000, v61
    v_mul_f32 v5, v5, v14
    v_mul_f32 v6, v6, v15
    v_cvt_pk_bf16_f32 v7, v5, v6
    v_lshlrev_b32 v5, 16, v7
    v_and_b32 v6, 0xffff0000, v7
    v_add_f32 v27, v27, v5
    v_add_f32 v27, v27, v6
    v_lshlrev_b32 v5, 16, v62
    v_and_b32 v6, 0xffff0000, v62
    v_mul_f32 v5, v5, v16
    v_mul_f32 v6, v6, v17
    v_cvt_pk_bf16_f32 v7, v5, v6
    v_lshlrev_b32 v5, 16, v7
    v_and_b32 v6, 0xffff0000, v7
    v_add_f32 v27, v27, v5
    v_add_f32 v27, v27, v6
    v_lshlrev_b32 v5, 16, v63
    v_and_b32 v6, 0xffff0000, v63
    v_mul_f32 v5, v5, v18
    v_mul_f32 v6, v6, v19
    v_cvt_pk_bf16_f32 v7, v5, v6
    v_lshlrev_b32 v5, 16, v7
    v_and_b32 v6, 0xffff0000, v7
    v_add_f32 v27, v27, v5
    v_add_f32 v27, v27, v6
    ds_swizzle_b32 v32, v20 offset:1055
    ds_swizzle_b32 v33, v21 offset:1055
    ds_swizzle_b32 v34, v22 offset:1055
    ds_swizzle_b32 v35, v23 offset:1055
    ds_swizzle_b32 v36, v24 offset:1055
    ds_swizzle_b32 v37, v25 offset:1055
    ds_swizzle_b32 v38, v26 offset:1055
    ds_swizzle_b32 v39, v27 offset:1055
    s_waitcnt lgkmcnt(0)
    v_add_f32 v20, v20, v32
    v_add_f32 v21, v21, v33
    v_add_f32 v22, v22, v34
    v_add_f32 v23, v23, v35
    v_add_f32 v24, v24, v36
    v_add_f32 v25, v25, v37
    v_add_f32 v26, v26, v38
    v_add_f32 v27, v27, v39
    ds_swizzle_b32 v32, v20 offset:2079
    ds_swizzle_b32 v33, v21 offset:2079
    ds_swizzle_b32 v34, v22 offset:2079
    ds_swizzle_b32 v35, v23 offset:2079
    ds_swizzle_b32 v36, v24 offset:2079
    ds_swizzle_b32 v37, v25 offset:2079
    ds_swizzle_b32 v38, v26 offset:2079
    ds_swizzle_b32 v39, v27 offset:2079
    s_waitcnt lgkmcnt(0)
    v_add_f32 v20, v20, v32
    v_add_f32 v21, v21, v33
    v_add_f32 v22, v22, v34
    v_add_f32 v23, v23, v35
    v_add_f32 v24, v24, v36
    v_add_f32 v25, v25, v37
    v_add_f32 v26, v26, v38
    v_add_f32 v27, v27, v39
    ds_swizzle_b32 v32, v20 offset:4127
    ds_swizzle_b32 v33, v21 offset:4127
    ds_swizzle_b32 v34, v22 offset:4127
    ds_swizzle_b32 v35, v23 offset:4127
    ds_swizzle_b32 v36, v24 offset:4127
    ds_swizzle_b32 v37, v25 offset:4127
    ds_swizzle_b32 v38, v26 offset:4127
    ds_swizzle_b32 v39, v27 offset:4127
    s_waitcnt lgkmcnt(0)
    v_add_f32 v20, v20, v32
    v_add_f32 v21, v21, v33
    v_add_f32 v22, v22, v34
    v_add_f32 v23, v23, v35
    v_add_f32 v24, v24, v36
    v_add_f32 v25, v25, v37
    v_add_f32 v26, v26, v38
    v_add_f32 v27, v27, v39
    ds_swizzle_b32 v32, v20 offset:8223
    ds_swizzle_b32 v33, v21 offset:8223
    ds_swizzle_b32 v34, v22 offset:8223
    ds_swizzle_b32 v35, v23 offset:8223
    ds_swizzle_b32 v36, v24 offset:8223
    ds_swizzle_b32 v37, v25 offset:8223
    ds_swizzle_b32 v38, v26 offset:8223
    ds_swizzle_b32 v39, v27 offset:8223
    s_waitcnt lgkmcnt(0)
    v_add_f32 v20, v20, v32
    v_add_f32 v21, v21, v33
    v_add_f32 v22, v22, v34
    v_add_f32 v23, v23, v35
    v_add_f32 v24, v24, v36
    v_add_f32 v25, v25, v37
    v_add_f32 v26, v26, v38
    v_add_f32 v27, v27, v39
    ds_swizzle_b32 v32, v20 offset:16415
    ds_swizzle_b32 v33, v21 offset:16415
    ds_swizzle_b32 v34, v22 offset:16415
    ds_swizzle_b32 v35, v23 offset:16415
    ds_swizzle_b32 v36, v24 offset:16415
    ds_swizzle_b32 v37, v25 offset:16415
    ds_swizzle_b32 v38, v26 offset:16415
    ds_swizzle_b32 v39, v27 offset:16415
    s_waitcnt lgkmcnt(0)
    v_add_f32 v20, v20, v32
    v_add_f32 v21, v21, v33
    v_add_f32 v22, v22, v34
    v_add_f32 v23, v23, v35
    v_add_f32 v24, v24, v36
    v_add_f32 v25, v25, v37
    v_add_f32 v26, v26, v38
    v_add_f32 v27, v27, v39
    v_mov_b32 v5, 0
    v_mov_b32 v6, 0
    s_nop 1
    v_readlane_b32 s38, v20, 0
    v_readlane_b32 s39, v20, 32
    s_nop 3
    v_writelane_b32 v5, s38, 0
    v_writelane_b32 v6, s39, 0
    v_readlane_b32 s38, v21, 0
    v_readlane_b32 s39, v21, 32
    s_nop 3
    v_writelane_b32 v5, s38, 1
    v_writelane_b32 v6, s39, 1
    v_readlane_b32 s38, v22, 0
    v_readlane_b32 s39, v22, 32
    s_nop 3
    v_writelane_b32 v5, s38, 2
    v_writelane_b32 v6, s39, 2
    v_readlane_b32 s38, v23, 0
    v_readlane_b32 s39, v23, 32
    s_nop 3
    v_writelane_b32 v5, s38, 3
    v_writelane_b32 v6, s39, 3
    v_readlane_b32 s38, v24, 0
    v_readlane_b32 s39, v24, 32
    s_nop 3
    v_writelane_b32 v5, s38, 4
    v_writelane_b32 v6, s39, 4
    v_readlane_b32 s38, v25, 0
    v_readlane_b32 s39, v25, 32
    s_nop 3
    v_writelane_b32 v5, s38, 5
    v_writelane_b32 v6, s39, 5
    v_readlane_b32 s38, v26, 0
    v_readlane_b32 s39, v26, 32
    s_nop 3
    v_writelane_b32 v5, s38, 6
    v_writelane_b32 v6, s39, 6
    v_readlane_b32 s38, v27, 0
    v_readlane_b32 s39, v27, 32
    s_nop 3
    v_writelane_b32 v5, s38, 7
    v_writelane_b32 v6, s39, 7
    s_nop 1
    v_add_f32 v5, v5, v6
    v_cvt_pk_bf16_f32 v5, v5, v5
    v_lshlrev_b32 v5, 16, v5
    v_mul_f32 v6, 0xbfb8aa3b, v5
    v_exp_f32 v6, v6
    s_nop 0
    v_add_f32 v6, 1.0, v6
    v_rcp_f32 v6, v6
    s_nop 0
    v_cvt_pk_bf16_f32 v6, v6, v6
    v_lshlrev_b32 v6, 16, v6
    s_lshl_b32 s38, s31, 5
    s_add_u32 s38, s38, 18874368
    v_lshlrev_b32 v7, 2, v1
    s_mov_b64 exec, 0xff
    buffer_store_dword v6, v7, s[16:19], s38 offen
    s_waitcnt vmcnt(0)
    s_endpgm
k1_kernel_end:
    s_endpgm
.section .rodata,"a"
.p2align 6
.amdhsa_kernel k1_kernel
  .amdhsa_next_free_vgpr 160
  .amdhsa_next_free_sgpr 102
  .amdhsa_accum_offset 160
  .amdhsa_group_segment_fixed_size 0
  .amdhsa_kernarg_size 96
  .amdhsa_user_sgpr_count 2
  .amdhsa_user_sgpr_kernarg_segment_ptr 1
  .amdhsa_system_sgpr_workgroup_id_x 1
.end_amdhsa_kernel
.text
.globl k2_kernel
.p2align 8
.type k2_kernel,@function
k2_kernel:
    s_cmp_ge_u32 s2, 256
    s_cbranch_scc1 k2_kernel_end
    s_load_dwordx2 s[4:5], s[0:1], 88
    v_and_b32 v1, 63, v0
    v_lshrrev_b32 v2, 6, v0
    s_nop 0
    v_readfirstlane_b32 s12, v2
    s_cmp_ge_u32 s12, 8
    s_cbranch_scc1 k2_kernel_gemm
    s_and_b32 s13, s2, 7
    s_lshl_b32 s13, s13, 2
    s_lshr_b32 s17, s2, 6
    s_add_u32 s13, s13, s17
    s_lshr_b32 s17, s2, 3
    s_and_b32 s17, s17, 7
    s_lshl_b32 s14, s17, 3
    s_add_u32 s14, s14, s12
    s_waitcnt lgkmcnt(0)
    s_mov_b32 s8, s4
    s_and_b32 s9, s5, 0xffff
    s_mov_b32 s10, 23068672
    s_mov_b32 s11, 0x20000
    s_lshl_b32 s16, s13, 7
    s_add_u32 s16, s16, 18939904
    s_load_dwordx16 s[48:63], s[4:5], s16
    s_add_u32 s16, s16, 64
    s_load_dwordx16 s[64:79], s[4:5], s16
    v_lshlrev_b32 v2, 4, v1
    s_lshl_b32 s16, s13, 16
    s_lshl_b32 s17, s14, 10
    s_add_u32 s16, s16, s17
    s_add_u32 s16, s16, 0
    buffer_load_dwordx4 v[104:107], v2, s[8:11], s16 offen
    s_lshl_b32 s15, s13, 17
    s_add_u32 s15, s15, 2097152
    s_lshl_b32 s18, s12, 10
    s_add_u32 s15, s15, s18
    s_add_u32 m0, s18, 0
    s_add_u32 s16, s15, 0
    buffer_load_dwordx4 v2, s[8:11], s16 offen lds
    s_add_u32 m0, s18, 8192
    s_add_u32 s16, s15, 8192
    buffer_load_dwordx4 v2, s[8:11], s16 offen lds
    s_add_u32 m0, s18, 16384
    s_add_u32 s16, s15, 16384
    buffer_load_dwordx4 v2, s[8:11], s16 offen lds
    s_add_u32 m0, s18, 24576
    s_add_u32 s16, s15, 24576
    buffer_load_dwordx4 v2, s[8:11], s16 offen lds
    s_add_u32 m0, s18, 32768
    s_add_u32 s16, s15, 32768
    buffer_load_dwordx4 v2, s[8:11], s16 offen lds
    s_add_u32 m0, s18, 40960
    s_add_u32 s16, s15, 40960
    buffer_load_dwordx4 v2, s[8:11], s16 offen lds
    s_add_u32 m0, s18, 49152
    s_add_u32 s16, s15, 49152
    buffer_load_dwordx4 v2, s[8:11], s16 offen lds
    s_add_u32 m0, s18, 57344
    s_add_u32 s16, s15, 57344
    buffer_load_dwordx4 v2, s[8:11], s16 offen lds
    s_add_u32 m0, s18, 65536
    s_add_u32 s16, s15, 65536
    buffer_load_dwordx4 v2, s[8:11], s16 offen lds
    s_add_u32 m0, s18, 73728
    s_add_u32 s16, s15, 73728
    buffer_load_dwordx4 v2, s[8:11], s16 offen lds
    s_add_u32 m0, s18, 81920
    s_add_u32 s16, s15, 81920
    buffer_load_dwordx4 v2, s[8:11], s16 offen lds
    s_add_u32 m0, s18, 90112
    s_add_u32 s16, s15, 90112
    buffer_load_dwordx4 v2, s[8:11], s16 offen lds
    s_add_u32 m0, s18, 98304
    s_add_u32 s16, s15, 98304
    buffer_load_dwordx4 v2, s[8:11], s16 offen lds
    s_add_u32 m0, s18, 106496
    s_add_u32 s16, s15, 106496
    buffer_load_dwordx4 v2, s[8:11], s16 offen lds
    s_add_u32 m0, s18, 114688
    s_add_u32 s16, s15, 114688
    buffer_load_dwordx4 v2, s[8:11], s16 offen lds
    s_add_u32 m0, s18, 122880
    s_add_u32 s16, s15, 122880
    buffer_load_dwordx4 v2, s[8:11], s16 offen lds
    v_mov_b32 v108, 0x3f803f80
    v_mov_b32 v109, 0x3f803f80
    v_mov_b32 v110, 0x3f803f80
    v_mov_b32 v111, 0x3f803f80
    s_lshl_b32 s17, s12, 10
    s_add_u32 s17, s17, 131072
    v_add_u32 v112, s17, v2
    ds_write_b128 v112, v[108:111]
    v_lshrrev_b32 v108, 5, v1
    v_lshlrev_b32 v108, 8, v108
    v_and_b32 v109, 15, v1
    v_lshl_add_u32 v108, v109, 4, v108
    v_lshrrev_b32 v109, 4, v1
    v_and_b32 v109, 1, v109
    v_mul_u32_u24 v110, 130048, v109
    v_add_u32 v110, 1024, v110
    v_add_u32 v3, v108, v110
    v_xor_b32 v109, 1, v109
    v_lshlrev_b32 v12, 12, v109
    s_waitcnt lgkmcnt(0)
    s_max_u32 s21, s48, s49
    s_max_u32 s21, s21, s50
    s_max_u32 s21, s21, s51
    s_max_u32 s21, s21, s52
    s_max_u32 s21, s21, s53
    s_max_u32 s21, s21, s54
    s_max_u32 s21, s21, s55
    s_max_u32 s21, s21, s56
    s_max_u32 s21, s21, s57
    s_max_u32 s21, s21, s58
    s_max_u32 s21, s21, s59
    s_max_u32 s21, s21, s60
    s_max_u32 s21, s21, s61
    s_max_u32 s21, s21, s62
    s_max_u32 s21, s21, s63
    s_max_u32 s21, s21, s64
    s_max_u32 s21, s21, s65
    s_max_u32 s21, s21, s66
    s_max_u32 s21, s21, s67
    s_max_u32 s21, s21, s68
    s_max_u32 s21, s21, s69
    s_max_u32 s21, s21, s70
    s_max_u32 s21, s21, s71
    s_max_u32 s21, s21, s72
    s_max_u32 s21, s21, s73
    s_max_u32 s21, s21, s74
    s_max_u32 s21, s21, s75
    s_max_u32 s21, s21, s76
    s_max_u32 s21, s21, s77
    s_max_u32 s21, s21, s78
    s_max_u32 s21, s21, s79
    s_waitcnt vmcnt(16)
    v_mov_b32 v112, 0
    v_dot2_f32_bf16 v112, v104, v104, v112
    v_dot2_f32_bf16 v112, v105, v105, v112
    v_dot2_f32_bf16 v112, v106, v106, v112
    v_dot2_f32_bf16 v112, v107, v107, v112
    s_nop 2
    v_mov_b32 v115, v112
    s_nop 1
    v_permlane32_swap_b32 v112, v115
    v_add_f32 v112, v112, v115
    v_mul_f32 v112, s21, v112
    v_sqrt_f32 v112, v112
    s_nop 0
    v_mul_f32 v112, 0x3eb8aa3b, v112
    v_sub_f32 v16, 0, v112
    v_sub_f32 v17, 0, v112
    v_sub_f32 v18, 0, v112
    v_sub_f32 v19, 0, v112
    v_sub_f32 v20, 0, v112
    v_sub_f32 v21, 0, v112
    v_sub_f32 v22, 0, v112
    v_sub_f32 v23, 0, v112
    v_sub_f32 v24, 0, v112
    v_sub_f32 v25, 0, v112
    v_sub_f32 v26, 0, v112
    v_sub_f32 v27, 0, v112
    v_sub_f32 v28, 0, v112
    v_sub_f32 v29, 0, v112
    v_sub_f32 v30, 0, v112
    v_sub_f32 v31, 0, v112
    v_lshlrev_b32 v108, 16, v104
    v_and_b32 v109, 0xffff0000, v104
    v_mul_f32 v108, 0x3eb8aa3b, v108
    v_mul_f32 v109, 0x3eb8aa3b, v109
    v_cvt_pk_bf16_f32 v4, v108, v109
    v_lshlrev_b32 v110, 16, v4
    v_and_b32 v111, 0xffff0000, v4
    v_sub_f32 v108, v108, v110
    v_sub_f32 v109, v109, v111
    v_cvt_pk_bf16_f32 v8, v108, v109
    v_lshlrev_b32 v108, 16, v105
    v_and_b32 v109, 0xffff0000, v105
    v_mul_f32 v108, 0x3eb8aa3b, v108
    v_mul_f32 v109, 0x3eb8aa3b, v109
    v_cvt_pk_bf16_f32 v5, v108, v109
    v_lshlrev_b32 v110, 16, v5
    v_and_b32 v111, 0xffff0000, v5
    v_sub_f32 v108, v108, v110
    v_sub_f32 v109, v109, v111
    v_cvt_pk_bf16_f32 v9, v108, v109
    v_lshlrev_b32 v108, 16, v106
    v_and_b32 v109, 0xffff0000, v106
    v_mul_f32 v108, 0x3eb8aa3b, v108
    v_mul_f32 v109, 0x3eb8aa3b, v109
    v_cvt_pk_bf16_f32 v6, v108, v109
    v_lshlrev_b32 v110, 16, v6
    v_and_b32 v111, 0xffff0000, v6
    v_sub_f32 v108, v108, v110
    v_sub_f32 v109, v109, v111
    v_cvt_pk_bf16_f32 v10, v108, v109
    v_lshlrev_b32 v108, 16, v107
    v_and_b32 v109, 0xffff0000, v107
    v_mul_f32 v108, 0x3eb8aa3b, v108
    v_mul_f32 v109, 0x3eb8aa3b, v109
    v_cvt_pk_bf16_f32 v7, v108, v109
    v_lshlrev_b32 v110, 16, v7
    v_and_b32 v111, 0xffff0000, v7
    v_sub_f32 v108, v108, v110
    v_sub_f32 v109, v109, v111
    v_cvt_pk_bf16_f32 v11, v108, v109
    s_mov_b32 s20, 0
    s_waitcnt vmcnt(14) lgkmcnt(0)
    s_barrier
k2_kernel_main:
    v_mov_b32 v64, 0
    v_mov_b32 v65, 0
    v_mov_b32 v66, 0
    v_mov_b32 v67, 0
    v_mov_b32 v68, 0
    v_mov_b32 v69, 0
    v_mov_b32 v70, 0
    v_mov_b32 v71, 0
    v_mov_b32 v72, 0
    v_mov_b32 v73, 0
    v_mov_b32 v74, 0
    v_mov_b32 v75, 0
    v_mov_b32 v76, 0
    v_mov_b32 v77, 0
    v_mov_b32 v78, 0
    v_mov_b32 v79, 0
    v_lshlrev_b32 v2, 4, v1
    ds_read_b128 v[80:83], v2
    ds_read_b128 v[84:87], v2 offset:2048
    ds_read_b128 v[88:91], v3
    ds_read_b128 v[92:95], v3 offset:512
    s_waitcnt lgkmcnt(3)
    v_mfma_f32_32x32x16_bf16 v[32:47], v[80:83], v[4:7], v[16:31]
    v_mfma_f32_32x32x16_bf16 v[32:47], v[80:83], v[8:11], v[32:47]
    s_nop 7
    s_nop 3
    s_mov_b32 s19, 0
k2_kernel_loop:
    s_cmp_lg_u32 s19, 3
    s_cbranch_scc1 k2_kernel_nosync
    s_cmp_lg_u32 s20, 0
    s_cbranch_scc1 k2_kernel_nosync
    s_waitcnt vmcnt(0)
    s_barrier
k2_kernel_nosync:
    ds_read_b128 v[80:83], v2 offset:4096
    v_exp_f32 v32, v32
    v_exp_f32 v33, v33
    v_exp_f32 v34, v34
    v_exp_f32 v35, v35
    v_exp_f32 v36, v36
    s_waitcnt lgkmcnt(3)
    v_mfma_f32_32x32x16_bf16 v[48:63], v[84:87], v[4:7], v[16:31]
    v_exp_f32 v37, v37
    v_exp_f32 v38, v38
    v_exp_f32 v39, v39
    v_cvt_pk_bf16_f32 v32, v32, v33
    v_cvt_pk_bf16_f32 v33, v34, v35
    v_cvt_pk_bf16_f32 v34, v36, v37
    v_cvt_pk_bf16_f32 v35, v38, v39
    s_waitcnt lgkmcnt(1)
    s_nop 0
    v_mfma_f32_32x32x16_bf16 v[64:79], v[88:91], v[32:35], v[64:79]
    v_exp_f32 v40, v40
    v_exp_f32 v41, v41
    v_exp_f32 v42, v42
    v_exp_f32 v43, v43
    v_mfma_f32_32x32x16_bf16 v[48:63], v[84:87], v[8:11], v[48:63]
    v_exp_f32 v44, v44
    v_exp_f32 v45, v45
    v_exp_f32 v46, v46
    v_exp_f32 v47, v47
    v_cvt_pk_bf16_f32 v36, v40, v41
    v_cvt_pk_bf16_f32 v37, v42, v43
    v_cvt_pk_bf16_f32 v38, v44, v45
    v_cvt_pk_bf16_f32 v39, v46, v47
    s_nop 1
    v_mfma_f32_32x32x16_bf16 v[64:79], v[92:95], v[36:39], v[64:79]
    ds_read_b128 v[96:99], v3 offset:2048
    ds_read_b128 v[100:103], v3 offset:2560
    ds_read_b128 v[84:87], v2 offset:6144
    v_exp_f32 v48, v48
    v_exp_f32 v49, v49
    v_exp_f32 v50, v50
    v_exp_f32 v51, v51
    v_exp_f32 v52, v52
    s_waitcnt lgkmcnt(3)
    v_mfma_f32_32x32x16_bf16 v[32:47], v[80:83], v[4:7], v[16:31]
    v_exp_f32 v53, v53
    v_exp_f32 v54, v54
    v_exp_f32 v55, v55
    v_cvt_pk_bf16_f32 v48, v48, v49
    v_cvt_pk_bf16_f32 v49, v50, v51
    v_cvt_pk_bf16_f32 v50, v52, v53
    v_cvt_pk_bf16_f32 v51, v54, v55
    s_waitcnt lgkmcnt(1)
    s_nop 0
    v_mfma_f32_32x32x16_bf16 v[64:79], v[96:99], v[48:51], v[64:79]
    v_exp_f32 v56, v56
    v_exp_f32 v57, v57
    v_exp_f32 v58, v58
    v_exp_f32 v59, v59
    v_mfma_f32_32x32x16_bf16 v[32:47], v[80:83], v[8:11], v[32:47]
    v_exp_f32 v60, v60
    v_exp_f32 v61, v61
    v_exp_f32 v62, v62
    v_exp_f32 v63, v63
    v_cvt_pk_bf16_f32 v52, v56, v57
    v_cvt_pk_bf16_f32 v53, v58, v59
    v_cvt_pk_bf16_f32 v54, v60, v61
    v_cvt_pk_bf16_f32 v55, v62, v63
    s_nop 1
    v_mfma_f32_32x32x16_bf16 v[64:79], v[100:103], v[52:55], v[64:79]
    ds_read_b128 v[88:91], v3 offset:4096
    ds_read_b128 v[92:95], v3 offset:4608
    v_add_u32 v2, 4096, v2
    v_add_u32 v3, v12, v3
    s_add_u32 s19, s19, 1
    s_cmp_lt_u32 s19, 32
    s_cbranch_scc1 k2_kernel_loop
    s_waitcnt lgkmcnt(0)
    s_nop 15
    v_mul_u32_u24 v108, 32, v12
    v_sub_u32 v3, v3, v108
    s_cmp_lg_u32 s20, 0
    s_cbranch_scc1 k2_kernel_finish
    v_cmp_nge_f32 vcc, 0x21800000, v72
    s_nop 3
    s_cmp_eq_u64 vcc, exec
    s_cbranch_scc1 k2_kernel_finish
    s_mov_b32 s20, 1
    v_mov_b32 v108, 0xff800000
    v_lshlrev_b32 v2, 4, v1
    s_mov_b32 s19, 0
k2_kernel_maxloop:
    ds_read_b128 v[80:83], v2
    s_waitcnt lgkmcnt(0)
    v_mfma_f32_32x32x16_bf16 v[32:47], v[80:83], v[4:7], 0
    v_mfma_f32_32x32x16_bf16 v[32:47], v[80:83], v[8:11], v[32:47]
    s_nop 15
    s_nop 3
    v_max3_f32 v108, v108, v32, v33
    v_max3_f32 v108, v108, v34, v35
    v_max3_f32 v108, v108, v36, v37
    v_max3_f32 v108, v108, v38, v39
    v_max3_f32 v108, v108, v40, v41
    v_max3_f32 v108, v108, v42, v43
    v_max3_f32 v108, v108, v44, v45
    v_max3_f32 v108, v108, v46, v47
    v_add_u32 v2, 2048, v2
    s_add_u32 s19, s19, 1
    s_cmp_lt_u32 s19, 64
    s_cbranch_scc1 k2_kernel_maxloop
    v_mov_b32 v109, v108
    s_nop 1
    v_permlane32_swap_b32 v108, v109
    v_max_f32 v108, v108, v109
    v_sub_f32 v16, 0, v108
    v_sub_f32 v17, 0, v108
    v_sub_f32 v18, 0, v108
    v_sub_f32 v19, 0, v108
    v_sub_f32 v20, 0, v108
    v_sub_f32 v21, 0, v108
    v_sub_f32 v22, 0, v108
    v_sub_f32 v23, 0, v108
    v_sub_f32 v24, 0, v108
    v_sub_f32 v25, 0, v108
    v_sub_f32 v26, 0, v108
    v_sub_f32 v27, 0, v108
    v_sub_f32 v28, 0, v108
    v_sub_f32 v29, 0, v108
    v_sub_f32 v30, 0, v108
    v_sub_f32 v31, 0, v108
    s_nop 1
    s_branch k2_kernel_main
k2_kernel_finish:
    v_rcp_f32 v108, v72
    s_nop 0
    v_mul_f32 v64, v64, v108
    v_mul_f32 v65, v65, v108
    v_mul_f32 v66, v66, v108
    v_mul_f32 v67, v67, v108
    v_mul_f32 v68, v68, v108
    v_mul_f32 v69, v69, v108
    v_mul_f32 v70, v70, v108
    v_mul_f32 v71, v71, v108
    v_cvt_pk_bf16_f32 v112, v64, v65
    v_cvt_pk_bf16_f32 v113, v66, v67
    v_cvt_pk_bf16_f32 v114, v68, v69
    v_cvt_pk_bf16_f32 v115, v70, v71
    s_lshl_b32 s16, s14, 5
    s_add_u32 s16, s16, s13
    s_lshl_b32 s16, s16, 10
    s_add_u32 s16, s16, 16777216
    v_lshlrev_b32 v109, 4, v1
    buffer_store_dwordx4 v[112:115], v109, s[8:11], s16 offen
    s_waitcnt vmcnt(0)
k2_kernel_end:
    s_endpgm
k2_kernel_gemm:
    s_load_dwordx2 s[76:77], s[0:1], 88
    s_load_dwordx2 s[78:79], s[0:1], 56
    v_lshlrev_b32 v48, 4, v1
    s_waitcnt lgkmcnt(0)
    s_mov_b32 s60, s76
    s_and_b32 s61, s77, 0xffff
    s_mov_b32 s62, 23068672
    s_mov_b32 s63, 0x20000
    s_mov_b32 s64, s78
    s_and_b32 s65, s79, 0xffff
    s_mov_b32 s66, 1024
    s_mov_b32 s67, 0x20000
    s_lshr_b32 s68, s2, 2
    s_and_b32 s69, s2, 3
    s_lshl_b32 s69, s69, 2
    s_add_u32 s69, s69, s12
    s_sub_u32 s69, s69, 8
    s_mul_i32 s70, s68, 114688
    s_add_u32 s70, s70, 6291456
    s_mul_i32 s71, s69, 114688
    s_add_u32 s71, s71, 13631488
    s_lshl_b32 s72, s69, 6
    v_lshrrev_b32 v49, 5, v1
    v_lshlrev_b32 v49, 3, v49
    buffer_load_dwordx2 v[112:113], v49, s[64:67], s72 offen offset:0
    buffer_load_dwordx2 v[114:115], v49, s[64:67], s72 offen offset:16
    buffer_load_dwordx2 v[116:117], v49, s[64:67], s72 offen offset:32
    buffer_load_dwordx2 v[118:119], v49, s[64:67], s72 offen offset:48
    v_mov_b32 v32, 0
    v_mov_b32 v33, 0
    v_mov_b32 v34, 0
    v_mov_b32 v35, 0
    v_mov_b32 v36, 0
    v_mov_b32 v37, 0
    v_mov_b32 v38, 0
    v_mov_b32 v39, 0
    v_mov_b32 v40, 0
    v_mov_b32 v41, 0
    v_mov_b32 v42, 0
    v_mov_b32 v43, 0
    v_mov_b32 v44, 0
    v_mov_b32 v45, 0
    v_mov_b32 v46, 0
    v_mov_b32 v47, 0
    s_barrier
    buffer_load_dwordx4 v[80:83], v48, s[60:63], s70 offen offset:0
    buffer_load_dwordx4 v[96:99], v48, s[60:63], s71 offen offset:0
    buffer_load_dwordx4 v[84:87], v48, s[60:63], s70 offen offset:1024
    buffer_load_dwordx4 v[100:103], v48, s[60:63], s71 offen offset:1024
    buffer_load_dwordx4 v[88:91], v48, s[60:63], s70 offen offset:2048
    buffer_load_dwordx4 v[104:107], v48, s[60:63], s71 offen offset:2048
    buffer_load_dwordx4 v[92:95], v48, s[60:63], s70 offen offset:3072
    buffer_load_dwordx4 v[108:111], v48, s[60:63], s71 offen offset:3072
    s_barrier
    s_mov_b32 s74, 0
k2_kernel_gl:
    s_add_u32 s72, s70, 4096
    s_add_u32 s73, s71, 4096
    s_waitcnt vmcnt(6)
    v_mfma_f32_32x32x16_bf16 v[32:47], v[96:99], v[80:83], v[32:47]
    buffer_load_dwordx4 v[80:83], v48, s[60:63], s72 offen offset:0
    buffer_load_dwordx4 v[96:99], v48, s[60:63], s73 offen offset:0
    s_waitcnt vmcnt(6)
    v_mfma_f32_32x32x16_bf16 v[32:47], v[100:103], v[84:87], v[32:47]
    buffer_load_dwordx4 v[84:87], v48, s[60:63], s72 offen offset:1024
    buffer_load_dwordx4 v[100:103], v48, s[60:63], s73 offen offset:1024
    s_waitcnt vmcnt(6)
    v_mfma_f32_32x32x16_bf16 v[32:47], v[104:107], v[88:91], v[32:47]
    buffer_load_dwordx4 v[88:91], v48, s[60:63], s72 offen offset:2048
    buffer_load_dwordx4 v[104:107], v48, s[60:63], s73 offen offset:2048
    s_waitcnt vmcnt(6)
    v_mfma_f32_32x32x16_bf16 v[32:47], v[108:111], v[92:95], v[32:47]
    buffer_load_dwordx4 v[92:95], v48, s[60:63], s72 offen offset:3072
    buffer_load_dwordx4 v[108:111], v48, s[60:63], s73 offen offset:3072
    s_mov_b32 s70, s72
    s_mov_b32 s71, s73
    s_add_u32 s74, s74, 1
    s_cmp_lt_u32 s74, 27
    s_cbranch_scc1 k2_kernel_gl
    s_waitcnt vmcnt(6)
    v_mfma_f32_32x32x16_bf16 v[32:47], v[96:99], v[80:83], v[32:47]
    s_waitcnt vmcnt(4)
    v_mfma_f32_32x32x16_bf16 v[32:47], v[100:103], v[84:87], v[32:47]
    s_waitcnt vmcnt(2)
    v_mfma_f32_32x32x16_bf16 v[32:47], v[104:107], v[88:91], v[32:47]
    s_waitcnt vmcnt(0)
    v_mfma_f32_32x32x16_bf16 v[32:47], v[108:111], v[92:95], v[32:47]
    s_nop 15
    s_nop 3
    v_and_b32 v50, 31, v1
    s_lshl_b32 s72, s68, 5
    v_add_u32 v50, s72, v50
    v_lshlrev_b32 v51, 10, v50
    v_lshrrev_b32 v52, 5, v1
    v_lshl_add_u32 v51, v52, 4, v51
    s_lshl_b32 s72, s69, 6
    s_add_u32 s72, s72, 19922944
    v_cvt_pk_bf16_f32 v53, v32, v33
    v_lshlrev_b32 v54, 16, v53
    v_and_b32 v55, 0xffff0000, v53
    v_lshlrev_b32 v32, 16, v112
    v_and_b32 v33, 0xffff0000, v112
    v_add_f32 v54, v54, v32
    v_add_f32 v55, v55, v33
    v_cvt_pk_bf16_f32 v120, v54, v55
    v_cvt_pk_bf16_f32 v53, v34, v35
    v_lshlrev_b32 v54, 16, v53
    v_and_b32 v55, 0xffff0000, v53
    v_lshlrev_b32 v34, 16, v113
    v_and_b32 v35, 0xffff0000, v113
    v_add_f32 v54, v54, v34
    v_add_f32 v55, v55, v35
    v_cvt_pk_bf16_f32 v121, v54, v55
    v_cvt_pk_bf16_f32 v53, v36, v37
    v_lshlrev_b32 v54, 16, v53
    v_and_b32 v55, 0xffff0000, v53
    v_lshlrev_b32 v36, 16, v114
    v_and_b32 v37, 0xffff0000, v114
    v_add_f32 v54, v54, v36
    v_add_f32 v55, v55, v37
    v_cvt_pk_bf16_f32 v122, v54, v55
    v_cvt_pk_bf16_f32 v53, v38, v39
    v_lshlrev_b32 v54, 16, v53
    v_and_b32 v55, 0xffff0000, v53
    v_lshlrev_b32 v38, 16, v115
    v_and_b32 v39, 0xffff0000, v115
    v_add_f32 v54, v54, v38
    v_add_f32 v55, v55, v39
    v_cvt_pk_bf16_f32 v123, v54, v55
    v_cvt_pk_bf16_f32 v53, v40, v41
    v_lshlrev_b32 v54, 16, v53
    v_and_b32 v55, 0xffff0000, v53
    v_lshlrev_b32 v40, 16, v116
    v_and_b32 v41, 0xffff0000, v116
    v_add_f32 v54, v54, v40
    v_add_f32 v55, v55, v41
    v_cvt_pk_bf16_f32 v124, v54, v55
    v_cvt_pk_bf16_f32 v53, v42, v43
    v_lshlrev_b32 v54, 16, v53
    v_and_b32 v55, 0xffff0000, v53
    v_lshlrev_b32 v42, 16, v117
    v_and_b32 v43, 0xffff0000, v117
    v_add_f32 v54, v54, v42
    v_add_f32 v55, v55, v43
    v_cvt_pk_bf16_f32 v125, v54, v55
    v_cvt_pk_bf16_f32 v53, v44, v45
    v_lshlrev_b32 v54, 16, v53
    v_and_b32 v55, 0xffff0000, v53
    v_lshlrev_b32 v44, 16, v118
    v_and_b32 v45, 0xffff0000, v118
    v_add_f32 v54, v54, v44
    v_add_f32 v55, v55, v45
    v_cvt_pk_bf16_f32 v126, v54, v55
    v_cvt_pk_bf16_f32 v53, v46, v47
    v_lshlrev_b32 v54, 16, v53
    v_and_b32 v55, 0xffff0000, v53
    v_lshlrev_b32 v46, 16, v119
    v_and_b32 v47, 0xffff0000, v119
    v_add_f32 v54, v54, v46
    v_add_f32 v55, v55, v47
    v_cvt_pk_bf16_f32 v127, v54, v55
    s_nop 1
    v_permlane32_swap_b32 v120, v122
    v_permlane32_swap_b32 v121, v123
    v_permlane32_swap_b32 v124, v126
    v_permlane32_swap_b32 v125, v127
    buffer_store_dwordx4 v[120:123], v51, s[60:63], s72 offen
    buffer_store_dwordx4 v[124:127], v51, s[60:63], s72 offen offset:32
    s_waitcnt vmcnt(0)
    s_endpgm
.section .rodata,"a"
.p2align 6
.amdhsa_kernel k2_kernel
  .amdhsa_next_free_vgpr 128
  .amdhsa_next_free_sgpr 102
  .amdhsa_accum_offset 128
  .amdhsa_group_segment_fixed_size 0
  .amdhsa_kernarg_size 96
  .amdhsa_user_sgpr_count 2
  .amdhsa_user_sgpr_kernarg_segment_ptr 1
  .amdhsa_system_sgpr_workgroup_id_x 1
.end_amdhsa_kernel
.text
.globl k3_kernel
.p2align 8
.type k3_kernel,@function
k3_kernel:
    s_cmp_ge_u32 s2, 256
    s_cbranch_scc1 k3_kernel_end
    s_load_dwordx2 s[4:5], s[0:1], 88
    s_load_dwordx2 s[6:7], s[0:1], 72
    v_and_b32 v1, 63, v0
    v_lshrrev_b32 v2, 6, v0
    s_nop 0
    v_readfirstlane_b32 s20, v2
    s_and_b32 s21, s2, 7
    s_lshl_b32 s21, s21, 2
    s_lshr_b32 s22, s2, 3
    s_and_b32 s22, s22, 3
    s_add_u32 s21, s21, s22
    s_lshr_b32 s22, s2, 5
    s_lshr_b32 s23, s20, 1
    s_and_b32 s24, s20, 1
    s_waitcnt lgkmcnt(0)
    s_mov_b32 s8, s4
    s_and_b32 s9, s5, 0xffff
    s_mov_b32 s10, 23068672
    s_mov_b32 s11, 0x20000
    s_mov_b32 s12, s6
    s_and_b32 s13, s7, 0xffff
    s_mov_b32 s14, 2097152
    s_mov_b32 s15, 0x20000
    v_lshlrev_b32 v2, 4, v1
    s_cmp_lt_u32 s20, 2
    s_cbranch_scc1 k3_kernel_astream
    s_lshl_b32 s28, s22, 1
    s_add_u32 s28, s28, s20
    s_sub_u32 s28, s28, 2
    s_mul_i32 s25, s28, 32768
    s_add_u32 s25, s25, 15466496
    s_branch k3_kernel_streamdone
k3_kernel_astream:
    s_lshl_b32 s28, s21, 1
    s_add_u32 s28, s28, s20
    s_mul_i32 s25, s28, 32768
    s_add_u32 s25, s25, 16777216
k3_kernel_streamdone:
    s_lshl_b32 s30, s20, 12
    s_add_u32 s27, s25, 0
    s_add_u32 m0, s30, 0
    s_nop 0
    buffer_load_dwordx4 v2, s[8:11], s27 offen offset:0 lds
    buffer_load_dwordx4 v2, s[8:11], s27 offen offset:1024 lds
    buffer_load_dwordx4 v2, s[8:11], s27 offen offset:2048 lds
    buffer_load_dwordx4 v2, s[8:11], s27 offen offset:3072 lds
    s_add_u32 s27, s25, 4096
    s_add_u32 m0, s30, 16384
    s_nop 0
    buffer_load_dwordx4 v2, s[8:11], s27 offen offset:0 lds
    buffer_load_dwordx4 v2, s[8:11], s27 offen offset:1024 lds
    buffer_load_dwordx4 v2, s[8:11], s27 offen offset:2048 lds
    buffer_load_dwordx4 v2, s[8:11], s27 offen offset:3072 lds
    s_add_u32 s27, s25, 8192
    s_add_u32 m0, s30, 32768
    s_nop 0
    buffer_load_dwordx4 v2, s[8:11], s27 offen offset:0 lds
    buffer_load_dwordx4 v2, s[8:11], s27 offen offset:1024 lds
    buffer_load_dwordx4 v2, s[8:11], s27 offen offset:2048 lds
    buffer_load_dwordx4 v2, s[8:11], s27 offen offset:3072 lds
    s_lshl_b32 s28, s23, 12
    v_add_u32 v96, s28, v2
    s_lshl_b32 s28, s24, 12
    s_add_u32 s28, s28, 8192
    v_add_u32 v100, s28, v2
    v_add_u32 v97, 16384, v96
    v_add_u32 v101, 16384, v100
    v_add_u32 v98, 32768, v96
    v_add_u32 v102, 32768, v100
    v_add_u32 v99, 49152, v96
    v_add_u32 v103, 49152, v100
    v_mov_b32 v32, 0
    v_mov_b32 v33, 0
    v_mov_b32 v34, 0
    v_mov_b32 v35, 0
    v_mov_b32 v36, 0
    v_mov_b32 v37, 0
    v_mov_b32 v38, 0
    v_mov_b32 v39, 0
    v_mov_b32 v40, 0
    v_mov_b32 v41, 0
    v_mov_b32 v42, 0
    v_mov_b32 v43, 0
    v_mov_b32 v44, 0
    v_mov_b32 v45, 0
    v_mov_b32 v46, 0
    v_mov_b32 v47, 0
    s_lshl_b32 s28, s21, 6
    s_lshl_b32 s29, s23, 5
    s_add_u32 s28, s28, s29
    v_and_b32 v80, 31, v1
    v_add_u32 v80, s28, v80
    v_lshlrev_b32 v81, 2, v80
    s_mov_b32 s27, 18874368
    buffer_load_dword v82, v81, s[8:11], s27 offen
    v_lshlrev_b32 v83, 10, v80
    v_lshrrev_b32 v84, 5, v1
    v_lshl_add_u32 v83, v84, 3, v83
    s_lshl_b32 s28, s22, 7
    s_lshl_b32 s29, s24, 6
    s_add_u32 s28, s28, s29
    s_add_u32 s28, s28, 19922944
    buffer_load_dwordx2 v[64:65], v83, s[8:11], s28 offen offset:0
    buffer_load_dwordx2 v[66:67], v83, s[8:11], s28 offen offset:16
    buffer_load_dwordx2 v[68:69], v83, s[8:11], s28 offen offset:32
    buffer_load_dwordx2 v[70:71], v83, s[8:11], s28 offen offset:48
    s_waitcnt vmcnt(13)
    s_barrier
    s_add_u32 s27, s25, 12288
    s_add_u32 m0, s30, 49152
    s_nop 0
    buffer_load_dwordx4 v2, s[8:11], s27 offen offset:0 lds
    buffer_load_dwordx4 v2, s[8:11], s27 offen offset:1024 lds
    buffer_load_dwordx4 v2, s[8:11], s27 offen offset:2048 lds
    buffer_load_dwordx4 v2, s[8:11], s27 offen offset:3072 lds
    ds_read_b128 v[8:11], v96 offset:0
    ds_read_b128 v[16:19], v100 offset:0
    ds_read_b128 v[12:15], v96 offset:1024
    ds_read_b128 v[20:23], v100 offset:1024
    s_waitcnt lgkmcnt(2)
    v_mfma_f32_32x32x16_bf16 v[32:47], v[16:19], v[8:11], v[32:47]
    ds_read_b128 v[8:11], v96 offset:2048
    ds_read_b128 v[16:19], v100 offset:2048
    s_waitcnt lgkmcnt(2)
    v_mfma_f32_32x32x16_bf16 v[32:47], v[20:23], v[12:15], v[32:47]
    ds_read_b128 v[12:15], v96 offset:3072
    ds_read_b128 v[20:23], v100 offset:3072
    s_waitcnt lgkmcnt(2)
    v_mfma_f32_32x32x16_bf16 v[32:47], v[16:19], v[8:11], v[32:47]
    s_waitcnt lgkmcnt(0)
    s_waitcnt vmcnt(13)
    s_barrier
    s_add_u32 s27, s25, 16384
    s_add_u32 m0, s30, 0
    s_nop 0
    buffer_load_dwordx4 v2, s[8:11], s27 offen offset:0 lds
    buffer_load_dwordx4 v2, s[8:11], s27 offen offset:1024 lds
    buffer_load_dwordx4 v2, s[8:11], s27 offen offset:2048 lds
    buffer_load_dwordx4 v2, s[8:11], s27 offen offset:3072 lds
    ds_read_b128 v[8:11], v97 offset:0
    ds_read_b128 v[16:19], v101 offset:0
    v_mfma_f32_32x32x16_bf16 v[32:47], v[20:23], v[12:15], v[32:47]
    ds_read_b128 v[12:15], v97 offset:1024
    ds_read_b128 v[20:23], v101 offset:1024
    s_waitcnt lgkmcnt(2)
    v_mfma_f32_32x32x16_bf16 v[32:47], v[16:19], v[8:11], v[32:47]
    ds_read_b128 v[8:11], v97 offset:2048
    ds_read_b128 v[16:19], v101 offset:2048
    s_waitcnt lgkmcnt(2)
    v_mfma_f32_32x32x16_bf16 v[32:47], v[20:23], v[12:15], v[32:47]
    ds_read_b128 v[12:15], v97 offset:3072
    ds_read_b128 v[20:23], v101 offset:3072
    s_waitcnt lgkmcnt(2)
    v_mfma_f32_32x32x16_bf16 v[32:47], v[16:19], v[8:11], v[32:47]
    s_waitcnt lgkmcnt(0)
    s_waitcnt vmcnt(13)
    s_barrier
    s_add_u32 s27, s25, 20480
    s_add_u32 m0, s30, 16384
    s_nop 0
    buffer_load_dwordx4 v2, s[8:11], s27 offen offset:0 lds
    buffer_load_dwordx4 v2, s[8:11], s27 offen offset:1024 lds
    buffer_load_dwordx4 v2, s[8:11], s27 offen offset:2048 lds
    buffer_load_dwordx4 v2, s[8:11], s27 offen offset:3072 lds
    ds_read_b128 v[8:11], v98 offset:0
    ds_read_b128 v[16:19], v102 offset:0
    v_mfma_f32_32x32x16_bf16 v[32:47], v[20:23], v[12:15], v[32:47]
    ds_read_b128 v[12:15], v98 offset:1024
    ds_read_b128 v[20:23], v102 offset:1024
    s_waitcnt lgkmcnt(2)
    v_mfma_f32_32x32x16_bf16 v[32:47], v[16:19], v[8:11], v[32:47]
    ds_read_b128 v[8:11], v98 offset:2048
    ds_read_b128 v[16:19], v102 offset:2048
    s_waitcnt lgkmcnt(2)
    v_mfma_f32_32x32x16_bf16 v[32:47], v[20:23], v[12:15], v[32:47]
    ds_read_b128 v[12:15], v98 offset:3072
    ds_read_b128 v[20:23], v102 offset:3072
    s_waitcnt lgkmcnt(2)
    v_mfma_f32_32x32x16_bf16 v[32:47], v[16:19], v[8:11], v[32:47]
    s_waitcnt lgkmcnt(0)
    s_waitcnt vmcnt(8)
    s_barrier
    s_add_u32 s27, s25, 24576
    s_add_u32 m0, s30, 32768
    s_nop 0
    buffer_load_dwordx4 v2, s[8:11], s27 offen offset:0 lds
    buffer_load_dwordx4 v2, s[8:11], s27 offen offset:1024 lds
    buffer_load_dwordx4 v2, s[8:11], s27 offen offset:2048 lds
    buffer_load_dwordx4 v2, s[8:11], s27 offen offset:3072 lds
    ds_read_b128 v[8:11], v99 offset:0
    ds_read_b128 v[16:19], v103 offset:0
    v_mfma_f32_32x32x16_bf16 v[32:47], v[20:23], v[12:15], v[32:47]
    ds_read_b128 v[12:15], v99 offset:1024
    ds_read_b128 v[20:23], v103 offset:1024
    s_waitcnt lgkmcnt(2)
    v_mfma_f32_32x32x16_bf16 v[32:47], v[16:19], v[8:11], v[32:47]
    ds_read_b128 v[8:11], v99 offset:2048
    ds_read_b128 v[16:19], v103 offset:2048
    s_waitcnt lgkmcnt(2)
    v_mfma_f32_32x32x16_bf16 v[32:47], v[20:23], v[12:15], v[32:47]
    ds_read_b128 v[12:15], v99 offset:3072
    ds_read_b128 v[20:23], v103 offset:3072
    s_waitcnt lgkmcnt(2)
    v_mfma_f32_32x32x16_bf16 v[32:47], v[16:19], v[8:11], v[32:47]
    s_waitcnt lgkmcnt(0)
    s_waitcnt vmcnt(8)
    s_barrier
    s_add_u32 s27, s25, 28672
    s_add_u32 m0, s30, 49152
    s_nop 0
    buffer_load_dwordx4 v2, s[8:11], s27 offen offset:0 lds
    buffer_load_dwordx4 v2, s[8:11], s27 offen offset:1024 lds
    buffer_load_dwordx4 v2, s[8:11], s27 offen offset:2048 lds
    buffer_load_dwordx4 v2, s[8:11], s27 offen offset:3072 lds
    ds_read_b128 v[8:11], v96 offset:0
    ds_read_b128 v[16:19], v100 offset:0
    v_mfma_f32_32x32x16_bf16 v[32:47], v[20:23], v[12:15], v[32:47]
    ds_read_b128 v[12:15], v96 offset:1024
    ds_read_b128 v[20:23], v100 offset:1024
    s_waitcnt lgkmcnt(2)
    v_mfma_f32_32x32x16_bf16 v[32:47], v[16:19], v[8:11], v[32:47]
    ds_read_b128 v[8:11], v96 offset:2048
    ds_read_b128 v[16:19], v100 offset:2048
    s_waitcnt lgkmcnt(2)
    v_mfma_f32_32x32x16_bf16 v[32:47], v[20:23], v[12:15], v[32:47]
    ds_read_b128 v[12:15], v96 offset:3072
    ds_read_b128 v[20:23], v100 offset:3072
    s_waitcnt lgkmcnt(2)
    v_mfma_f32_32x32x16_bf16 v[32:47], v[16:19], v[8:11], v[32:47]
    s_waitcnt lgkmcnt(0)
    s_waitcnt vmcnt(8)
    s_barrier
    ds_read_b128 v[8:11], v97 offset:0
    ds_read_b128 v[16:19], v101 offset:0
    v_mfma_f32_32x32x16_bf16 v[32:47], v[20:23], v[12:15], v[32:47]
    ds_read_b128 v[12:15], v97 offset:1024
    ds_read_b128 v[20:23], v101 offset:1024
    s_waitcnt lgkmcnt(2)
    v_mfma_f32_32x32x16_bf16 v[32:47], v[16:19], v[8:11], v[32:47]
    ds_read_b128 v[8:11], v97 offset:2048
    ds_read_b128 v[16:19], v101 offset:2048
    s_waitcnt lgkmcnt(2)
    v_mfma_f32_32x32x16_bf16 v[32:47], v[20:23], v[12:15], v[32:47]
    ds_read_b128 v[12:15], v97 offset:3072
    ds_read_b128 v[20:23], v101 offset:3072
    s_waitcnt lgkmcnt(2)
    v_mfma_f32_32x32x16_bf16 v[32:47], v[16:19], v[8:11], v[32:47]
    s_waitcnt lgkmcnt(0)
    s_waitcnt vmcnt(4)
    s_barrier
    ds_read_b128 v[8:11], v98 offset:0
    ds_read_b128 v[16:19], v102 offset:0
    v_mfma_f32_32x32x16_bf16 v[32:47], v[20:23], v[12:15], v[32:47]
    ds_read_b128 v[12:15], v98 offset:1024
    ds_read_b128 v[20:23], v102 offset:1024
    s_waitcnt lgkmcnt(2)
    v_mfma_f32_32x32x16_bf16 v[32:47], v[16:19], v[8:11], v[32:47]
    ds_read_b128 v[8:11], v98 offset:2048
    ds_read_b128 v[16:19], v102 offset:2048
    s_waitcnt lgkmcnt(2)
    v_mfma_f32_32x32x16_bf16 v[32:47], v[20:23], v[12:15], v[32:47]
    ds_read_b128 v[12:15], v98 offset:3072
    ds_read_b128 v[20:23], v102 offset:3072
    s_waitcnt lgkmcnt(2)
    v_mfma_f32_32x32x16_bf16 v[32:47], v[16:19], v[8:11], v[32:47]
    s_waitcnt lgkmcnt(0)
    s_waitcnt vmcnt(0)
    s_barrier
    ds_read_b128 v[8:11], v99 offset:0
    ds_read_b128 v[16:19], v103 offset:0
    v_mfma_f32_32x32x16_bf16 v[32:47], v[20:23], v[12:15], v[32:47]
    ds_read_b128 v[12:15], v99 offset:1024
    ds_read_b128 v[20:23], v103 offset:1024
    s_waitcnt lgkmcnt(2)
    v_mfma_f32_32x32x16_bf16 v[32:47], v[16:19], v[8:11], v[32:47]
    ds_read_b128 v[8:11], v99 offset:2048
    ds_read_b128 v[16:19], v103 offset:2048
    s_waitcnt lgkmcnt(2)
    v_mfma_f32_32x32x16_bf16 v[32:47], v[20:23], v[12:15], v[32:47]
    ds_read_b128 v[12:15], v99 offset:3072
    ds_read_b128 v[20:23], v103 offset:3072
    s_waitcnt lgkmcnt(2)
    v_mfma_f32_32x32x16_bf16 v[32:47], v[16:19], v[8:11], v[32:47]
    s_waitcnt lgkmcnt(0)
    s_waitcnt vmcnt(0)
    v_mfma_f32_32x32x16_bf16 v[32:47], v[20:23], v[12:15], v[32:47]
    s_nop 15
    s_nop 3
    v_sub_f32 v85, 1.0, v82
    v_cvt_pk_bf16_f32 v85, v85, v85
    v_lshlrev_b32 v85, 16, v85
    v_cvt_pk_bf16_f32 v90, v32, v33
    v_lshlrev_b32 v86, 16, v90
    v_and_b32 v87, 0xffff0000, v90
    v_mul_f32 v86, v82, v86
    v_mul_f32 v87, v82, v87
    v_cvt_pk_bf16_f32 v90, v86, v87
    v_lshlrev_b32 v86, 16, v90
    v_and_b32 v87, 0xffff0000, v90
    v_lshlrev_b32 v88, 16, v64
    v_and_b32 v89, 0xffff0000, v64
    v_mul_f32 v88, v85, v88
    v_mul_f32 v89, v85, v89
    v_cvt_pk_bf16_f32 v90, v88, v89
    v_lshlrev_b32 v88, 16, v90
    v_and_b32 v89, 0xffff0000, v90
    v_add_f32 v86, v86, v88
    v_add_f32 v87, v87, v89
    v_cvt_pk_bf16_f32 v72, v86, v87
    v_cvt_pk_bf16_f32 v90, v34, v35
    v_lshlrev_b32 v86, 16, v90
    v_and_b32 v87, 0xffff0000, v90
    v_mul_f32 v86, v82, v86
    v_mul_f32 v87, v82, v87
    v_cvt_pk_bf16_f32 v90, v86, v87
    v_lshlrev_b32 v86, 16, v90
    v_and_b32 v87, 0xffff0000, v90
    v_lshlrev_b32 v88, 16, v65
    v_and_b32 v89, 0xffff0000, v65
    v_mul_f32 v88, v85, v88
    v_mul_f32 v89, v85, v89
    v_cvt_pk_bf16_f32 v90, v88, v89
    v_lshlrev_b32 v88, 16, v90
    v_and_b32 v89, 0xffff0000, v90
    v_add_f32 v86, v86, v88
    v_add_f32 v87, v87, v89
    v_cvt_pk_bf16_f32 v73, v86, v87
    v_cvt_pk_bf16_f32 v90, v36, v37
    v_lshlrev_b32 v86, 16, v90
    v_and_b32 v87, 0xffff0000, v90
    v_mul_f32 v86, v82, v86
    v_mul_f32 v87, v82, v87
    v_cvt_pk_bf16_f32 v90, v86, v87
    v_lshlrev_b32 v86, 16, v90
    v_and_b32 v87, 0xffff0000, v90
    v_lshlrev_b32 v88, 16, v66
    v_and_b32 v89, 0xffff0000, v66
    v_mul_f32 v88, v85, v88
    v_mul_f32 v89, v85, v89
    v_cvt_pk_bf16_f32 v90, v88, v89
    v_lshlrev_b32 v88, 16, v90
    v_and_b32 v89, 0xffff0000, v90
    v_add_f32 v86, v86, v88
    v_add_f32 v87, v87, v89
    v_cvt_pk_bf16_f32 v74, v86, v87
    v_cvt_pk_bf16_f32 v90, v38, v39
    v_lshlrev_b32 v86, 16, v90
    v_and_b32 v87, 0xffff0000, v90
    v_mul_f32 v86, v82, v86
    v_mul_f32 v87, v82, v87
    v_cvt_pk_bf16_f32 v90, v86, v87
    v_lshlrev_b32 v86, 16, v90
    v_and_b32 v87, 0xffff0000, v90
    v_lshlrev_b32 v88, 16, v67
    v_and_b32 v89, 0xffff0000, v67
    v_mul_f32 v88, v85, v88
    v_mul_f32 v89, v85, v89
    v_cvt_pk_bf16_f32 v90, v88, v89
    v_lshlrev_b32 v88, 16, v90
    v_and_b32 v89, 0xffff0000, v90
    v_add_f32 v86, v86, v88
    v_add_f32 v87, v87, v89
    v_cvt_pk_bf16_f32 v75, v86, v87
    v_cvt_pk_bf16_f32 v90, v40, v41
    v_lshlrev_b32 v86, 16, v90
    v_and_b32 v87, 0xffff0000, v90
    v_mul_f32 v86, v82, v86
    v_mul_f32 v87, v82, v87
    v_cvt_pk_bf16_f32 v90, v86, v87
    v_lshlrev_b32 v86, 16, v90
    v_and_b32 v87, 0xffff0000, v90
    v_lshlrev_b32 v88, 16, v68
    v_and_b32 v89, 0xffff0000, v68
    v_mul_f32 v88, v85, v88
    v_mul_f32 v89, v85, v89
    v_cvt_pk_bf16_f32 v90, v88, v89
    v_lshlrev_b32 v88, 16, v90
    v_and_b32 v89, 0xffff0000, v90
    v_add_f32 v86, v86, v88
    v_add_f32 v87, v87, v89
    v_cvt_pk_bf16_f32 v76, v86, v87
    v_cvt_pk_bf16_f32 v90, v42, v43
    v_lshlrev_b32 v86, 16, v90
    v_and_b32 v87, 0xffff0000, v90
    v_mul_f32 v86, v82, v86
    v_mul_f32 v87, v82, v87
    v_cvt_pk_bf16_f32 v90, v86, v87
    v_lshlrev_b32 v86, 16, v90
    v_and_b32 v87, 0xffff0000, v90
    v_lshlrev_b32 v88, 16, v69
    v_and_b32 v89, 0xffff0000, v69
    v_mul_f32 v88, v85, v88
    v_mul_f32 v89, v85, v89
    v_cvt_pk_bf16_f32 v90, v88, v89
    v_lshlrev_b32 v88, 16, v90
    v_and_b32 v89, 0xffff0000, v90
    v_add_f32 v86, v86, v88
    v_add_f32 v87, v87, v89
    v_cvt_pk_bf16_f32 v77, v86, v87
    v_cvt_pk_bf16_f32 v90, v44, v45
    v_lshlrev_b32 v86, 16, v90
    v_and_b32 v87, 0xffff0000, v90
    v_mul_f32 v86, v82, v86
    v_mul_f32 v87, v82, v87
    v_cvt_pk_bf16_f32 v90, v86, v87
    v_lshlrev_b32 v86, 16, v90
    v_and_b32 v87, 0xffff0000, v90
    v_lshlrev_b32 v88, 16, v70
    v_and_b32 v89, 0xffff0000, v70
    v_mul_f32 v88, v85, v88
    v_mul_f32 v89, v85, v89
    v_cvt_pk_bf16_f32 v90, v88, v89
    v_lshlrev_b32 v88, 16, v90
    v_and_b32 v89, 0xffff0000, v90
    v_add_f32 v86, v86, v88
    v_add_f32 v87, v87, v89
    v_cvt_pk_bf16_f32 v78, v86, v87
    v_cvt_pk_bf16_f32 v90, v46, v47
    v_lshlrev_b32 v86, 16, v90
    v_and_b32 v87, 0xffff0000, v90
    v_mul_f32 v86, v82, v86
    v_mul_f32 v87, v82, v87
    v_cvt_pk_bf16_f32 v90, v86, v87
    v_lshlrev_b32 v86, 16, v90
    v_and_b32 v87, 0xffff0000, v90
    v_lshlrev_b32 v88, 16, v71
    v_and_b32 v89, 0xffff0000, v71
    v_mul_f32 v88, v85, v88
    v_mul_f32 v89, v85, v89
    v_cvt_pk_bf16_f32 v90, v88, v89
    v_lshlrev_b32 v88, 16, v90
    v_and_b32 v89, 0xffff0000, v90
    v_add_f32 v86, v86, v88
    v_add_f32 v87, v87, v89
    v_cvt_pk_bf16_f32 v79, v86, v87
    s_nop 1
    v_permlane32_swap_b32 v72, v74
    v_permlane32_swap_b32 v73, v75
    v_permlane32_swap_b32 v76, v78
    v_permlane32_swap_b32 v77, v79
    v_lshlrev_b32 v91, 10, v80
    v_lshrrev_b32 v92, 5, v1
    v_lshl_add_u32 v91, v92, 4, v91
    s_lshl_b32 s28, s22, 7
    s_lshl_b32 s29, s24, 6
    s_add_u32 s28, s28, s29
    buffer_store_dwordx4 v[72:75], v91, s[12:15], s28 offen
    buffer_store_dwordx4 v[76:79], v91, s[12:15], s28 offen offset:32
    s_waitcnt vmcnt(0)
k3_kernel_end:
    s_endpgm
.section .rodata,"a"
.p2align 6
.amdhsa_kernel k3_kernel
  .amdhsa_next_free_vgpr 104
  .amdhsa_next_free_sgpr 102
  .amdhsa_accum_offset 104
  .amdhsa_group_segment_fixed_size 0
  .amdhsa_kernarg_size 96
  .amdhsa_user_sgpr_count 2
  .amdhsa_user_sgpr_kernarg_segment_ptr 1
  .amdhsa_system_sgpr_workgroup_id_x 1
.end_amdhsa_kernel
.text
```
